```python
import torch

def _softmax(x, axis=-1):
    return torch.softmax(x, dim=axis)
def _gelu(x):
    return torch.nn.functional.gelu(x, approximate="tanh")
def _silu(x):
    return torch.nn.functional.silu(x)
def _sigmoid(x):
    return torch.sigmoid(x)
def _layernorm(x, axis=-1, eps=1e-5):
    m = x.mean(dim=axis, keepdim=True)
    v = x.var(dim=axis, keepdim=True, unbiased=False)
    return (x - m) / torch.sqrt(v + eps)
def _scatter_add(tgt, idx, src, axis=0):
    return tgt.clone().index_add_(axis, idx, src)
def _segment_sum(src, seg, n):
    out = torch.zeros((n,) + src.shape[1:], dtype=src.dtype)
    return out.index_add_(0, seg, src)
def _pad(x, pw):
    flat = tuple(v for pair in reversed(pw) for v in pair)
    return torch.nn.functional.pad(x, flat)

kernel_name = 'standalone__mha_block_cached__near_ridge'

def setup_inputs():

    _w = (lambda a: (lambda t: t.to(torch.bfloat16) if t.is_floating_point() else t)(torch.as_tensor(a)))
    B, Sq, D = 16, 96, 640
    H, Sk, Dh = 32, 1024, 192
    return {
        "x": _w((lambda *s: torch.randn(*s, dtype=torch.bfloat16) * 0.8)(B, Sq, D)),
        "k_cache": _w((lambda *s: torch.randn(*s, dtype=torch.bfloat16) * 0.8)(B, H, Sk, Dh)),
        "v_cache": _w((lambda *s: torch.randn(*s, dtype=torch.bfloat16) * 0.05)(B, H, Sk, Dh)),
        "wq": _w((lambda *s: torch.randn(*s, dtype=torch.bfloat16) * 0.8)(D, H * Dh) * (D ** -0.5)),
        "wo": _w((lambda *s: torch.randn(*s, dtype=torch.bfloat16) * 0.05)(H * Dh, D) * ((H * Dh) ** -0.5)),
    }

def reference(x, k_cache, v_cache, wq, wo):
    B, Sq, D = x.shape
    H, Dh = 32, 192
    q = (lambda x, *d: x.permute(*d))((x @ wq).reshape(B, Sq, H, Dh), 0, 2, 1, 3)
    scores = torch.einsum("bhqd,bhkd->bhqk", q, k_cache) * (Dh ** -0.5)
    p = _softmax(scores, axis=-1)
    o = torch.einsum("bhqk,bhkd->bhqd", p, v_cache)
    return (lambda x, *d: x.permute(*d))(o, 0, 2, 1, 3).reshape(B, Sq, H * Dh) @ wo
```

```asm
; @launch kernel=attn_kernel grid=(256,1,1) block=(512,1,1) lds=159744
; @launch kernel=oproj_kernel grid=(240,1,1) block=(512,1,1) lds=131072
.amdgcn_target "amdgcn-amd-amdhsa--gfx950"
.text
.globl attn_kernel
.p2align 8
.type attn_kernel,@function
attn_kernel:
    s_cmp_ge_u32 s2, 256
    s_cbranch_scc1 A_done
    s_load_dwordx8 s[36:43], s[0:1], 0
    s_load_dwordx2 s[44:45], s[0:1], 56
    v_lshrrev_b32 v1, 6, v0
    v_and_b32 v0, 63, v0
    s_lshr_b32 s4, s2, 5
    s_and_b32 s5, s2, 7
    s_lshl_b32 s5, s5, 2
    s_bfe_u32 s7, s2, 0x20003
    s_add_u32 s5, s5, s7
    v_readfirstlane_b32 s3, v1
    s_lshl_b32 s6, s4, 5
    s_add_u32 s6, s6, s5
    s_mul_i32 s6, s6, 393216
    s_waitcnt lgkmcnt(0)
    s_mov_b32 s8, s38
    s_and_b32 s9, s39, 0xffff
    s_mov_b32 s10, 201326592
    s_mov_b32 s11, 0x00020000
    s_mov_b32 s12, s40
    s_and_b32 s13, s41, 0xffff
    s_mov_b32 s14, 201326592
    s_mov_b32 s15, 0x00020000
    s_mov_b32 s16, s42
    s_and_b32 s17, s43, 0xffff
    s_mov_b32 s18, 7864320
    s_mov_b32 s19, 0x00020000
    s_mov_b32 s20, s36
    s_and_b32 s21, s37, 0xffff
    s_mov_b32 s22, 1966080
    s_mov_b32 s23, 0x00020000
    s_mov_b32 s24, s44
    s_and_b32 s25, s45, 0xffff
    s_mov_b32 s26, 18874368
    s_mov_b32 s27, 0x00020000
    s_cmp_eq_u32 s3, 3
    s_cbranch_scc1 A_loadK
    s_cmp_eq_u32 s3, 7
    s_cbranch_scc1 A_loadV
    s_and_b32 s9, s3, 3
    s_lshr_b32 s10, s3, 2
    s_mul_i32 s11, s10, 3
    s_add_u32 s11, s11, s9
    s_lshl_b32 s7, s11, 7
    v_add_u32 v214, s7, v0
    v_mul_u32_u24 v215, 2731, v214
    v_lshrrev_b32 v215, 16, v215
    v_mul_u32_u24 v217, 24, v215
    v_sub_u32 v216, v214, v217
    v_bfe_u32 v217, v215, 1, 1
    v_lshlrev_b32 v217, 2, v217
    v_xor_b32 v216, v216, v217
    v_mul_u32_u24 v215, 12288, v215
    v_lshl_add_u32 v2, v216, 4, v215
    v_add_u32 v214, s7, v0
    v_add_u32 v214, 64, v214
    v_mul_u32_u24 v215, 2731, v214
    v_lshrrev_b32 v215, 16, v215
    v_mul_u32_u24 v217, 24, v215
    v_sub_u32 v216, v214, v217
    v_bfe_u32 v217, v215, 1, 1
    v_lshlrev_b32 v217, 2, v217
    v_xor_b32 v216, v216, v217
    v_mul_u32_u24 v215, 12288, v215
    v_lshl_add_u32 v3, v216, 4, v215
    v_add_u32 v214, 0, v0
    v_lshrrev_b32 v215, 3, v214
    v_and_b32 v216, 7, v214
    v_bfe_u32 v217, v215, 1, 3
    v_xor_b32 v216, v216, v217
    v_mul_u32_u24 v215, 1280, v215
    v_lshl_add_u32 v15, v216, 4, v215
    v_add_u32 v214, 64, v0
    v_lshrrev_b32 v215, 3, v214
    v_and_b32 v216, 7, v214
    v_bfe_u32 v217, v215, 1, 3
    v_xor_b32 v216, v216, v217
    v_mul_u32_u24 v215, 1280, v215
    v_lshl_add_u32 v16, v216, 4, v215
    v_add_u32 v214, 128, v0
    v_lshrrev_b32 v215, 3, v214
    v_and_b32 v216, 7, v214
    v_bfe_u32 v217, v215, 1, 3
    v_xor_b32 v216, v216, v217
    v_mul_u32_u24 v215, 1280, v215
    v_lshl_add_u32 v17, v216, 4, v215
    v_add_u32 v214, 192, v0
    v_lshrrev_b32 v215, 3, v214
    v_and_b32 v216, 7, v214
    v_bfe_u32 v217, v215, 1, 3
    v_xor_b32 v216, v216, v217
    v_mul_u32_u24 v215, 1280, v215
    v_lshl_add_u32 v18, v216, 4, v215
    s_mul_i32 s29, s5, 384
    s_lshl_b32 s7, s10, 3
    s_add_u32 s7, s7, s4
    s_mul_i32 s30, s7, 122880
    s_mul_i32 s7, s9, 40960
    s_add_u32 s30, s30, s7
    s_lshl_b32 s28, s11, 11
    s_lshl_b32 s48, s11, 12
    s_add_u32 s31, s29, 0
    s_add_u32 m0, s28, 122880
    s_nop 0
    buffer_load_dwordx4 v2, s[16:19], s31 offen lds
    s_add_u32 m0, s28, 123904
    s_nop 0
    buffer_load_dwordx4 v3, s[16:19], s31 offen lds
    s_add_u32 s31, s30, 0
    s_add_u32 m0, s48, 61440
    s_nop 0
    buffer_load_dwordx4 v15, s[20:23], s31 offen lds
    s_add_u32 m0, s48, 62464
    s_nop 0
    buffer_load_dwordx4 v16, s[20:23], s31 offen lds
    s_add_u32 m0, s48, 63488
    s_nop 0
    buffer_load_dwordx4 v17, s[20:23], s31 offen lds
    s_add_u32 m0, s48, 64512
    s_nop 0
    buffer_load_dwordx4 v18, s[20:23], s31 offen lds
    s_add_u32 s31, s29, 393216
    s_add_u32 m0, s28, 135168
    s_nop 0
    buffer_load_dwordx4 v2, s[16:19], s31 offen lds
    s_add_u32 m0, s28, 136192
    s_nop 0
    buffer_load_dwordx4 v3, s[16:19], s31 offen lds
    s_add_u32 s31, s29, 786432
    s_add_u32 m0, s28, 147456
    s_nop 0
    buffer_load_dwordx4 v2, s[16:19], s31 offen lds
    s_add_u32 m0, s28, 148480
    s_nop 0
    buffer_load_dwordx4 v3, s[16:19], s31 offen lds
    s_add_u32 s31, s30, 128
    s_add_u32 m0, s48, 86016
    s_nop 0
    buffer_load_dwordx4 v15, s[20:23], s31 offen lds
    s_add_u32 m0, s48, 87040
    s_nop 0
    buffer_load_dwordx4 v16, s[20:23], s31 offen lds
    s_add_u32 m0, s48, 88064
    s_nop 0
    buffer_load_dwordx4 v17, s[20:23], s31 offen lds
    s_add_u32 m0, s48, 89088
    s_nop 0
    buffer_load_dwordx4 v18, s[20:23], s31 offen lds
    s_add_u32 s31, s29, 1179648
    s_add_u32 m0, s28, 110592
    s_nop 0
    buffer_load_dwordx4 v2, s[16:19], s31 offen lds
    s_add_u32 m0, s28, 111616
    s_nop 0
    buffer_load_dwordx4 v3, s[16:19], s31 offen lds
    v_and_b32 v208, 31, v0
    v_lshrrev_b32 v209, 5, v0
    v_and_b32 v210, 15, v0
    v_bfe_u32 v211, v0, 4, 1
    v_lshrrev_b32 v212, 2, v210
    v_and_b32 v213, 3, v210
    v_bfe_u32 v214, v208, 1, 3
    v_xor_b32 v214, v209, v214
    v_mul_u32_u24 v215, 384, v208
    v_lshl_add_u32 v217, v208, 7, s48
    v_add_u32 v217, 61440, v217
    v_xor_b32 v216, 0, v214
    v_lshl_add_u32 v4, v216, 4, v215
    v_lshl_add_u32 v20, v216, 4, v217
    v_xor_b32 v216, 2, v214
    v_lshl_add_u32 v5, v216, 4, v215
    v_lshl_add_u32 v21, v216, 4, v217
    v_xor_b32 v216, 4, v214
    v_lshl_add_u32 v6, v216, 4, v215
    v_lshl_add_u32 v22, v216, 4, v217
    v_xor_b32 v216, 6, v214
    v_lshl_add_u32 v7, v216, 4, v215
    v_lshl_add_u32 v23, v216, 4, v217
    v_lshl_add_u32 v214, v209, 2, v212
    v_mul_u32_u24 v214, 384, v214
    v_lshrrev_b32 v215, 1, v213
    v_lshl_add_u32 v215, v211, 1, v215
    v_lshl_add_u32 v214, v215, 4, v214
    v_and_b32 v215, 1, v213
    v_lshl_add_u32 v214, v215, 3, v214
    v_lshrrev_b32 v215, 1, v212
    v_lshlrev_b32 v215, 6, v215
    v_add_u32 v8, v214, v215
    v_sub_u32 v9, v214, v215
    v_lshl_add_u32 v214, v209, 3, v212
    v_mul_u32_u24 v214, 384, v214
    v_and_b32 v216, 1, v213
    v_lshl_add_u32 v216, v211, 1, v216
    v_lshl_add_u32 v214, v216, 4, v214
    v_lshrrev_b32 v216, 1, v213
    v_lshl_add_u32 v214, v216, 3, v214
    v_add_u32 v214, 110592, v214
    v_add_u32 v11, v214, v215
    v_sub_u32 v12, v214, v215
    s_mul_i32 s7, s9, 12288
    s_add_u32 s7, s7, 122880
    v_lshl_add_u32 v1, v0, 4, s7
    s_waitcnt vmcnt(10)
    s_barrier
    ds_read_b128 v[168:171], v20 offset:0
    ds_read_b128 v[172:175], v21 offset:0
    ds_read_b64_tr_b16 v[208:209], v11 offset:12288
    ds_read_b64_tr_b16 v[210:211], v11 offset:13824
    ds_read_b64_tr_b16 v[212:213], v12 offset:12352
    ds_read_b64_tr_b16 v[214:215], v12 offset:13888
    ds_read_b64_tr_b16 v[216:217], v11 offset:12416
    ds_read_b64_tr_b16 v[218:219], v11 offset:13952
    ds_read_b64_tr_b16 v[220:221], v12 offset:12480
    ds_read_b64_tr_b16 v[222:223], v12 offset:14016
    ds_read_b64_tr_b16 v[224:225], v11 offset:12544
    ds_read_b64_tr_b16 v[226:227], v11 offset:14080
    ds_read_b64_tr_b16 v[228:229], v12 offset:12608
    ds_read_b64_tr_b16 v[230:231], v12 offset:14144
    ds_read_b64_tr_b16 v[232:233], v11 offset:18432
    ds_read_b64_tr_b16 v[234:235], v11 offset:19968
    ds_read_b64_tr_b16 v[236:237], v12 offset:18496
    ds_read_b64_tr_b16 v[238:239], v12 offset:20032
    ds_read_b64_tr_b16 v[240:241], v11 offset:18560
    ds_read_b64_tr_b16 v[242:243], v11 offset:20096
    ds_read_b64_tr_b16 v[244:245], v12 offset:18624
    ds_read_b64_tr_b16 v[246:247], v12 offset:20160
    ds_read_b64_tr_b16 v[248:249], v11 offset:18688
    ds_read_b64_tr_b16 v[250:251], v11 offset:20224
    ds_read_b64_tr_b16 v[252:253], v12 offset:18752
    ds_read_b64_tr_b16 v[254:255], v12 offset:20288
    s_waitcnt lgkmcnt(0)
    s_waitcnt vmcnt(8)
    s_barrier
    ds_read_b128 v[176:179], v22 offset:0
    ds_read_b128 v[180:183], v23 offset:0
    v_mfma_f32_32x32x16_bf16 v[72:87], v[208:211], v[168:171], 0
    ds_read_b64_tr_b16 v[208:209], v11 offset:24576
    ds_read_b64_tr_b16 v[210:211], v11 offset:26112
    v_mfma_f32_32x32x16_bf16 v[88:103], v[212:215], v[168:171], 0
    ds_read_b64_tr_b16 v[212:213], v12 offset:24640
    ds_read_b64_tr_b16 v[214:215], v12 offset:26176
    v_mfma_f32_32x32x16_bf16 v[104:119], v[216:219], v[168:171], 0
    ds_read_b64_tr_b16 v[216:217], v11 offset:24704
    ds_read_b64_tr_b16 v[218:219], v11 offset:26240
    v_mfma_f32_32x32x16_bf16 v[120:135], v[220:223], v[168:171], 0
    ds_read_b64_tr_b16 v[220:221], v12 offset:24768
    ds_read_b64_tr_b16 v[222:223], v12 offset:26304
    v_mfma_f32_32x32x16_bf16 v[136:151], v[224:227], v[168:171], 0
    ds_read_b64_tr_b16 v[224:225], v11 offset:24832
    ds_read_b64_tr_b16 v[226:227], v11 offset:26368
    v_mfma_f32_32x32x16_bf16 v[152:167], v[228:231], v[168:171], 0
    ds_read_b64_tr_b16 v[228:229], v12 offset:24896
    ds_read_b64_tr_b16 v[230:231], v12 offset:26432
    v_mfma_f32_32x32x16_bf16 v[72:87], v[232:235], v[172:175], v[72:87]
    ds_read_b64_tr_b16 v[232:233], v11 offset:30720
    ds_read_b64_tr_b16 v[234:235], v11 offset:32256
    v_mfma_f32_32x32x16_bf16 v[88:103], v[236:239], v[172:175], v[88:103]
    ds_read_b64_tr_b16 v[236:237], v12 offset:30784
    ds_read_b64_tr_b16 v[238:239], v12 offset:32320
    v_mfma_f32_32x32x16_bf16 v[104:119], v[240:243], v[172:175], v[104:119]
    ds_read_b64_tr_b16 v[240:241], v11 offset:30848
    ds_read_b64_tr_b16 v[242:243], v11 offset:32384
    v_mfma_f32_32x32x16_bf16 v[120:135], v[244:247], v[172:175], v[120:135]
    ds_read_b64_tr_b16 v[244:245], v12 offset:30912
    ds_read_b64_tr_b16 v[246:247], v12 offset:32448
    v_mfma_f32_32x32x16_bf16 v[136:151], v[248:251], v[172:175], v[136:151]
    ds_read_b64_tr_b16 v[248:249], v11 offset:30976
    ds_read_b64_tr_b16 v[250:251], v11 offset:32512
    v_mfma_f32_32x32x16_bf16 v[152:167], v[252:255], v[172:175], v[152:167]
    ds_read_b64_tr_b16 v[252:253], v12 offset:31040
    ds_read_b64_tr_b16 v[254:255], v12 offset:32576
    s_waitcnt lgkmcnt(0)
    s_waitcnt vmcnt(2)
    s_barrier
    ds_read_b128 v[168:171], v20 offset:24576
    ds_read_b128 v[172:175], v21 offset:24576
    v_mfma_f32_32x32x16_bf16 v[72:87], v[208:211], v[176:179], v[72:87]
    ds_read_b64_tr_b16 v[208:209], v11 offset:36864
    ds_read_b64_tr_b16 v[210:211], v11 offset:38400
    v_mfma_f32_32x32x16_bf16 v[88:103], v[212:215], v[176:179], v[88:103]
    ds_read_b64_tr_b16 v[212:213], v12 offset:36928
    ds_read_b64_tr_b16 v[214:215], v12 offset:38464
    v_mfma_f32_32x32x16_bf16 v[104:119], v[216:219], v[176:179], v[104:119]
    ds_read_b64_tr_b16 v[216:217], v11 offset:36992
    ds_read_b64_tr_b16 v[218:219], v11 offset:38528
    v_mfma_f32_32x32x16_bf16 v[120:135], v[220:223], v[176:179], v[120:135]
    ds_read_b64_tr_b16 v[220:221], v12 offset:37056
    ds_read_b64_tr_b16 v[222:223], v12 offset:38592
    v_mfma_f32_32x32x16_bf16 v[136:151], v[224:227], v[176:179], v[136:151]
    ds_read_b64_tr_b16 v[224:225], v11 offset:37120
    ds_read_b64_tr_b16 v[226:227], v11 offset:38656
    v_mfma_f32_32x32x16_bf16 v[152:167], v[228:231], v[176:179], v[152:167]
    ds_read_b64_tr_b16 v[228:229], v12 offset:37184
    ds_read_b64_tr_b16 v[230:231], v12 offset:38720
    v_mfma_f32_32x32x16_bf16 v[72:87], v[232:235], v[180:183], v[72:87]
    ds_read_b64_tr_b16 v[232:233], v11 offset:43008
    ds_read_b64_tr_b16 v[234:235], v11 offset:44544
    v_mfma_f32_32x32x16_bf16 v[88:103], v[236:239], v[180:183], v[88:103]
    ds_read_b64_tr_b16 v[236:237], v12 offset:43072
    ds_read_b64_tr_b16 v[238:239], v12 offset:44608
    v_mfma_f32_32x32x16_bf16 v[104:119], v[240:243], v[180:183], v[104:119]
    ds_read_b64_tr_b16 v[240:241], v11 offset:43136
    ds_read_b64_tr_b16 v[242:243], v11 offset:44672
    v_mfma_f32_32x32x16_bf16 v[120:135], v[244:247], v[180:183], v[120:135]
    ds_read_b64_tr_b16 v[244:245], v12 offset:43200
    ds_read_b64_tr_b16 v[246:247], v12 offset:44736
    v_mfma_f32_32x32x16_bf16 v[136:151], v[248:251], v[180:183], v[136:151]
    ds_read_b64_tr_b16 v[248:249], v11 offset:43264
    ds_read_b64_tr_b16 v[250:251], v11 offset:44800
    v_mfma_f32_32x32x16_bf16 v[152:167], v[252:255], v[180:183], v[152:167]
    ds_read_b64_tr_b16 v[252:253], v12 offset:43328
    ds_read_b64_tr_b16 v[254:255], v12 offset:44864
    s_waitcnt lgkmcnt(0)
    s_waitcnt vmcnt(0)
    s_barrier
    ds_read_b128 v[176:179], v22 offset:24576
    ds_read_b128 v[180:183], v23 offset:24576
    v_mfma_f32_32x32x16_bf16 v[72:87], v[208:211], v[168:171], v[72:87]
    ds_read_b64_tr_b16 v[208:209], v11 offset:0
    ds_read_b64_tr_b16 v[210:211], v11 offset:1536
    v_mfma_f32_32x32x16_bf16 v[88:103], v[212:215], v[168:171], v[88:103]
    ds_read_b64_tr_b16 v[212:213], v12 offset:64
    ds_read_b64_tr_b16 v[214:215], v12 offset:1600
    v_mfma_f32_32x32x16_bf16 v[104:119], v[216:219], v[168:171], v[104:119]
    ds_read_b64_tr_b16 v[216:217], v11 offset:128
    ds_read_b64_tr_b16 v[218:219], v11 offset:1664
    v_mfma_f32_32x32x16_bf16 v[120:135], v[220:223], v[168:171], v[120:135]
    ds_read_b64_tr_b16 v[220:221], v12 offset:192
    ds_read_b64_tr_b16 v[222:223], v12 offset:1728
    v_mfma_f32_32x32x16_bf16 v[136:151], v[224:227], v[168:171], v[136:151]
    ds_read_b64_tr_b16 v[224:225], v11 offset:256
    ds_read_b64_tr_b16 v[226:227], v11 offset:1792
    v_mfma_f32_32x32x16_bf16 v[152:167], v[228:231], v[168:171], v[152:167]
    ds_read_b64_tr_b16 v[228:229], v12 offset:320
    ds_read_b64_tr_b16 v[230:231], v12 offset:1856
    v_mfma_f32_32x32x16_bf16 v[72:87], v[232:235], v[172:175], v[72:87]
    ds_read_b64_tr_b16 v[232:233], v11 offset:6144
    ds_read_b64_tr_b16 v[234:235], v11 offset:7680
    v_mfma_f32_32x32x16_bf16 v[88:103], v[236:239], v[172:175], v[88:103]
    ds_read_b64_tr_b16 v[236:237], v12 offset:6208
    ds_read_b64_tr_b16 v[238:239], v12 offset:7744
    v_mfma_f32_32x32x16_bf16 v[104:119], v[240:243], v[172:175], v[104:119]
    ds_read_b64_tr_b16 v[240:241], v11 offset:6272
    ds_read_b64_tr_b16 v[242:243], v11 offset:7808
    v_mfma_f32_32x32x16_bf16 v[120:135], v[244:247], v[172:175], v[120:135]
    ds_read_b64_tr_b16 v[244:245], v12 offset:6336
    ds_read_b64_tr_b16 v[246:247], v12 offset:7872
    v_mfma_f32_32x32x16_bf16 v[136:151], v[248:251], v[172:175], v[136:151]
    ds_read_b64_tr_b16 v[248:249], v11 offset:6400
    ds_read_b64_tr_b16 v[250:251], v11 offset:7936
    v_mfma_f32_32x32x16_bf16 v[152:167], v[252:255], v[172:175], v[152:167]
    ds_read_b64_tr_b16 v[252:253], v12 offset:6464
    ds_read_b64_tr_b16 v[254:255], v12 offset:8000
    s_waitcnt lgkmcnt(0)
    s_barrier
    ds_read_b128 v[168:171], v20 offset:0
    ds_read_b128 v[172:175], v21 offset:0
    v_mfma_f32_32x32x16_bf16 v[72:87], v[208:211], v[176:179], v[72:87]
    ds_read_b64_tr_b16 v[208:209], v11 offset:12288
    ds_read_b64_tr_b16 v[210:211], v11 offset:13824
    v_mfma_f32_32x32x16_bf16 v[88:103], v[212:215], v[176:179], v[88:103]
    ds_read_b64_tr_b16 v[212:213], v12 offset:12352
    ds_read_b64_tr_b16 v[214:215], v12 offset:13888
    v_mfma_f32_32x32x16_bf16 v[104:119], v[216:219], v[176:179], v[104:119]
    ds_read_b64_tr_b16 v[216:217], v11 offset:12416
    ds_read_b64_tr_b16 v[218:219], v11 offset:13952
    v_mfma_f32_32x32x16_bf16 v[120:135], v[220:223], v[176:179], v[120:135]
    ds_read_b64_tr_b16 v[220:221], v12 offset:12480
    ds_read_b64_tr_b16 v[222:223], v12 offset:14016
    v_mfma_f32_32x32x16_bf16 v[136:151], v[224:227], v[176:179], v[136:151]
    ds_read_b64_tr_b16 v[224:225], v11 offset:12544
    ds_read_b64_tr_b16 v[226:227], v11 offset:14080
    v_mfma_f32_32x32x16_bf16 v[152:167], v[228:231], v[176:179], v[152:167]
    ds_read_b64_tr_b16 v[228:229], v12 offset:12608
    ds_read_b64_tr_b16 v[230:231], v12 offset:14144
    v_mfma_f32_32x32x16_bf16 v[72:87], v[232:235], v[180:183], v[72:87]
    ds_read_b64_tr_b16 v[232:233], v11 offset:18432
    ds_read_b64_tr_b16 v[234:235], v11 offset:19968
    v_mfma_f32_32x32x16_bf16 v[88:103], v[236:239], v[180:183], v[88:103]
    ds_read_b64_tr_b16 v[236:237], v12 offset:18496
    ds_read_b64_tr_b16 v[238:239], v12 offset:20032
    v_mfma_f32_32x32x16_bf16 v[104:119], v[240:243], v[180:183], v[104:119]
    ds_read_b64_tr_b16 v[240:241], v11 offset:18560
    ds_read_b64_tr_b16 v[242:243], v11 offset:20096
    v_mfma_f32_32x32x16_bf16 v[120:135], v[244:247], v[180:183], v[120:135]
    ds_read_b64_tr_b16 v[244:245], v12 offset:18624
    ds_read_b64_tr_b16 v[246:247], v12 offset:20160
    v_mfma_f32_32x32x16_bf16 v[136:151], v[248:251], v[180:183], v[136:151]
    ds_read_b64_tr_b16 v[248:249], v11 offset:18688
    ds_read_b64_tr_b16 v[250:251], v11 offset:20224
    v_mfma_f32_32x32x16_bf16 v[152:167], v[252:255], v[180:183], v[152:167]
    ds_read_b64_tr_b16 v[252:253], v12 offset:18752
    ds_read_b64_tr_b16 v[254:255], v12 offset:20288
    s_waitcnt lgkmcnt(0)
    s_barrier
    ds_read_b128 v[176:179], v22 offset:0
    ds_read_b128 v[180:183], v23 offset:0
    v_mfma_f32_32x32x16_bf16 v[72:87], v[208:211], v[168:171], v[72:87]
    ds_read_b64_tr_b16 v[208:209], v11 offset:24576
    ds_read_b64_tr_b16 v[210:211], v11 offset:26112
    v_mfma_f32_32x32x16_bf16 v[88:103], v[212:215], v[168:171], v[88:103]
    ds_read_b64_tr_b16 v[212:213], v12 offset:24640
    ds_read_b64_tr_b16 v[214:215], v12 offset:26176
    v_mfma_f32_32x32x16_bf16 v[104:119], v[216:219], v[168:171], v[104:119]
    ds_read_b64_tr_b16 v[216:217], v11 offset:24704
    ds_read_b64_tr_b16 v[218:219], v11 offset:26240
    v_mfma_f32_32x32x16_bf16 v[120:135], v[220:223], v[168:171], v[120:135]
    ds_read_b64_tr_b16 v[220:221], v12 offset:24768
    ds_read_b64_tr_b16 v[222:223], v12 offset:26304
    v_mfma_f32_32x32x16_bf16 v[136:151], v[224:227], v[168:171], v[136:151]
    ds_read_b64_tr_b16 v[224:225], v11 offset:24832
    ds_read_b64_tr_b16 v[226:227], v11 offset:26368
    v_mfma_f32_32x32x16_bf16 v[152:167], v[228:231], v[168:171], v[152:167]
    ds_read_b64_tr_b16 v[228:229], v12 offset:24896
    ds_read_b64_tr_b16 v[230:231], v12 offset:26432
    v_mfma_f32_32x32x16_bf16 v[72:87], v[232:235], v[172:175], v[72:87]
    ds_read_b64_tr_b16 v[232:233], v11 offset:30720
    ds_read_b64_tr_b16 v[234:235], v11 offset:32256
    v_mfma_f32_32x32x16_bf16 v[88:103], v[236:239], v[172:175], v[88:103]
    ds_read_b64_tr_b16 v[236:237], v12 offset:30784
    ds_read_b64_tr_b16 v[238:239], v12 offset:32320
    v_mfma_f32_32x32x16_bf16 v[104:119], v[240:243], v[172:175], v[104:119]
    ds_read_b64_tr_b16 v[240:241], v11 offset:30848
    ds_read_b64_tr_b16 v[242:243], v11 offset:32384
    v_mfma_f32_32x32x16_bf16 v[120:135], v[244:247], v[172:175], v[120:135]
    ds_read_b64_tr_b16 v[244:245], v12 offset:30912
    ds_read_b64_tr_b16 v[246:247], v12 offset:32448
    v_mfma_f32_32x32x16_bf16 v[136:151], v[248:251], v[172:175], v[136:151]
    ds_read_b64_tr_b16 v[248:249], v11 offset:30976
    ds_read_b64_tr_b16 v[250:251], v11 offset:32512
    v_mfma_f32_32x32x16_bf16 v[152:167], v[252:255], v[172:175], v[152:167]
    ds_read_b64_tr_b16 v[252:253], v12 offset:31040
    ds_read_b64_tr_b16 v[254:255], v12 offset:32576
    s_waitcnt lgkmcnt(0)
    s_barrier
    ds_read_b128 v[168:171], v20 offset:24576
    ds_read_b128 v[172:175], v21 offset:24576
    v_mfma_f32_32x32x16_bf16 v[72:87], v[208:211], v[176:179], v[72:87]
    ds_read_b64_tr_b16 v[208:209], v11 offset:36864
    ds_read_b64_tr_b16 v[210:211], v11 offset:38400
    v_mfma_f32_32x32x16_bf16 v[88:103], v[212:215], v[176:179], v[88:103]
    ds_read_b64_tr_b16 v[212:213], v12 offset:36928
    ds_read_b64_tr_b16 v[214:215], v12 offset:38464
    v_mfma_f32_32x32x16_bf16 v[104:119], v[216:219], v[176:179], v[104:119]
    ds_read_b64_tr_b16 v[216:217], v11 offset:36992
    ds_read_b64_tr_b16 v[218:219], v11 offset:38528
    v_mfma_f32_32x32x16_bf16 v[120:135], v[220:223], v[176:179], v[120:135]
    ds_read_b64_tr_b16 v[220:221], v12 offset:37056
    ds_read_b64_tr_b16 v[222:223], v12 offset:38592
    v_mfma_f32_32x32x16_bf16 v[136:151], v[224:227], v[176:179], v[136:151]
    ds_read_b64_tr_b16 v[224:225], v11 offset:37120
    ds_read_b64_tr_b16 v[226:227], v11 offset:38656
    v_mfma_f32_32x32x16_bf16 v[152:167], v[228:231], v[176:179], v[152:167]
    ds_read_b64_tr_b16 v[228:229], v12 offset:37184
    ds_read_b64_tr_b16 v[230:231], v12 offset:38720
    v_mfma_f32_32x32x16_bf16 v[72:87], v[232:235], v[180:183], v[72:87]
    ds_read_b64_tr_b16 v[232:233], v11 offset:43008
    ds_read_b64_tr_b16 v[234:235], v11 offset:44544
    v_mfma_f32_32x32x16_bf16 v[88:103], v[236:239], v[180:183], v[88:103]
    ds_read_b64_tr_b16 v[236:237], v12 offset:43072
    ds_read_b64_tr_b16 v[238:239], v12 offset:44608
    v_mfma_f32_32x32x16_bf16 v[104:119], v[240:243], v[180:183], v[104:119]
    ds_read_b64_tr_b16 v[240:241], v11 offset:43136
    ds_read_b64_tr_b16 v[242:243], v11 offset:44672
    v_mfma_f32_32x32x16_bf16 v[120:135], v[244:247], v[180:183], v[120:135]
    ds_read_b64_tr_b16 v[244:245], v12 offset:43200
    ds_read_b64_tr_b16 v[246:247], v12 offset:44736
    v_mfma_f32_32x32x16_bf16 v[136:151], v[248:251], v[180:183], v[136:151]
    ds_read_b64_tr_b16 v[248:249], v11 offset:43264
    ds_read_b64_tr_b16 v[250:251], v11 offset:44800
    v_mfma_f32_32x32x16_bf16 v[152:167], v[252:255], v[180:183], v[152:167]
    ds_read_b64_tr_b16 v[252:253], v12 offset:43328
    ds_read_b64_tr_b16 v[254:255], v12 offset:44864
    s_waitcnt lgkmcnt(0)
    s_barrier
    ds_read_b128 v[176:179], v22 offset:24576
    ds_read_b128 v[180:183], v23 offset:24576
    v_mfma_f32_32x32x16_bf16 v[72:87], v[208:211], v[168:171], v[72:87]
    ds_read_b64_tr_b16 v[208:209], v11 offset:0
    ds_read_b64_tr_b16 v[210:211], v11 offset:1536
    v_mfma_f32_32x32x16_bf16 v[88:103], v[212:215], v[168:171], v[88:103]
    ds_read_b64_tr_b16 v[212:213], v12 offset:64
    ds_read_b64_tr_b16 v[214:215], v12 offset:1600
    v_mfma_f32_32x32x16_bf16 v[104:119], v[216:219], v[168:171], v[104:119]
    ds_read_b64_tr_b16 v[216:217], v11 offset:128
    ds_read_b64_tr_b16 v[218:219], v11 offset:1664
    v_mfma_f32_32x32x16_bf16 v[120:135], v[220:223], v[168:171], v[120:135]
    ds_read_b64_tr_b16 v[220:221], v12 offset:192
    ds_read_b64_tr_b16 v[222:223], v12 offset:1728
    v_mfma_f32_32x32x16_bf16 v[136:151], v[224:227], v[168:171], v[136:151]
    ds_read_b64_tr_b16 v[224:225], v11 offset:256
    ds_read_b64_tr_b16 v[226:227], v11 offset:1792
    v_mfma_f32_32x32x16_bf16 v[152:167], v[228:231], v[168:171], v[152:167]
    ds_read_b64_tr_b16 v[228:229], v12 offset:320
    ds_read_b64_tr_b16 v[230:231], v12 offset:1856
    v_mfma_f32_32x32x16_bf16 v[72:87], v[232:235], v[172:175], v[72:87]
    ds_read_b64_tr_b16 v[232:233], v11 offset:6144
    ds_read_b64_tr_b16 v[234:235], v11 offset:7680
    v_mfma_f32_32x32x16_bf16 v[88:103], v[236:239], v[172:175], v[88:103]
    ds_read_b64_tr_b16 v[236:237], v12 offset:6208
    ds_read_b64_tr_b16 v[238:239], v12 offset:7744
    v_mfma_f32_32x32x16_bf16 v[104:119], v[240:243], v[172:175], v[104:119]
    ds_read_b64_tr_b16 v[240:241], v11 offset:6272
    ds_read_b64_tr_b16 v[242:243], v11 offset:7808
    v_mfma_f32_32x32x16_bf16 v[120:135], v[244:247], v[172:175], v[120:135]
    ds_read_b64_tr_b16 v[244:245], v12 offset:6336
    ds_read_b64_tr_b16 v[246:247], v12 offset:7872
    v_mfma_f32_32x32x16_bf16 v[136:151], v[248:251], v[172:175], v[136:151]
    ds_read_b64_tr_b16 v[248:249], v11 offset:6400
    ds_read_b64_tr_b16 v[250:251], v11 offset:7936
    v_mfma_f32_32x32x16_bf16 v[152:167], v[252:255], v[172:175], v[152:167]
    ds_read_b64_tr_b16 v[252:253], v12 offset:6464
    ds_read_b64_tr_b16 v[254:255], v12 offset:8000
    s_waitcnt lgkmcnt(0)
    s_barrier
    ds_read_b128 v[168:171], v20 offset:0
    ds_read_b128 v[172:175], v21 offset:0
    v_mfma_f32_32x32x16_bf16 v[72:87], v[208:211], v[176:179], v[72:87]
    ds_read_b64_tr_b16 v[208:209], v11 offset:12288
    ds_read_b64_tr_b16 v[210:211], v11 offset:13824
    v_mfma_f32_32x32x16_bf16 v[88:103], v[212:215], v[176:179], v[88:103]
    ds_read_b64_tr_b16 v[212:213], v12 offset:12352
    ds_read_b64_tr_b16 v[214:215], v12 offset:13888
    v_mfma_f32_32x32x16_bf16 v[104:119], v[216:219], v[176:179], v[104:119]
    ds_read_b64_tr_b16 v[216:217], v11 offset:12416
    ds_read_b64_tr_b16 v[218:219], v11 offset:13952
    v_mfma_f32_32x32x16_bf16 v[120:135], v[220:223], v[176:179], v[120:135]
    ds_read_b64_tr_b16 v[220:221], v12 offset:12480
    ds_read_b64_tr_b16 v[222:223], v12 offset:14016
    v_mfma_f32_32x32x16_bf16 v[136:151], v[224:227], v[176:179], v[136:151]
    ds_read_b64_tr_b16 v[224:225], v11 offset:12544
    ds_read_b64_tr_b16 v[226:227], v11 offset:14080
    v_mfma_f32_32x32x16_bf16 v[152:167], v[228:231], v[176:179], v[152:167]
    ds_read_b64_tr_b16 v[228:229], v12 offset:12608
    ds_read_b64_tr_b16 v[230:231], v12 offset:14144
    v_mfma_f32_32x32x16_bf16 v[72:87], v[232:235], v[180:183], v[72:87]
    ds_read_b64_tr_b16 v[232:233], v11 offset:18432
    ds_read_b64_tr_b16 v[234:235], v11 offset:19968
    v_mfma_f32_32x32x16_bf16 v[88:103], v[236:239], v[180:183], v[88:103]
    ds_read_b64_tr_b16 v[236:237], v12 offset:18496
    ds_read_b64_tr_b16 v[238:239], v12 offset:20032
    v_mfma_f32_32x32x16_bf16 v[104:119], v[240:243], v[180:183], v[104:119]
    ds_read_b64_tr_b16 v[240:241], v11 offset:18560
    ds_read_b64_tr_b16 v[242:243], v11 offset:20096
    v_mfma_f32_32x32x16_bf16 v[120:135], v[244:247], v[180:183], v[120:135]
    ds_read_b64_tr_b16 v[244:245], v12 offset:18624
    ds_read_b64_tr_b16 v[246:247], v12 offset:20160
    v_mfma_f32_32x32x16_bf16 v[136:151], v[248:251], v[180:183], v[136:151]
    ds_read_b64_tr_b16 v[248:249], v11 offset:18688
    ds_read_b64_tr_b16 v[250:251], v11 offset:20224
    v_mfma_f32_32x32x16_bf16 v[152:167], v[252:255], v[180:183], v[152:167]
    ds_read_b64_tr_b16 v[252:253], v12 offset:18752
    ds_read_b64_tr_b16 v[254:255], v12 offset:20288
    s_waitcnt lgkmcnt(0)
    s_barrier
    ds_read_b128 v[176:179], v22 offset:0
    ds_read_b128 v[180:183], v23 offset:0
    v_mfma_f32_32x32x16_bf16 v[72:87], v[208:211], v[168:171], v[72:87]
    ds_read_b64_tr_b16 v[208:209], v11 offset:24576
    ds_read_b64_tr_b16 v[210:211], v11 offset:26112
    v_mfma_f32_32x32x16_bf16 v[88:103], v[212:215], v[168:171], v[88:103]
    ds_read_b64_tr_b16 v[212:213], v12 offset:24640
    ds_read_b64_tr_b16 v[214:215], v12 offset:26176
    v_mfma_f32_32x32x16_bf16 v[104:119], v[216:219], v[168:171], v[104:119]
    ds_read_b64_tr_b16 v[216:217], v11 offset:24704
    ds_read_b64_tr_b16 v[218:219], v11 offset:26240
    v_mfma_f32_32x32x16_bf16 v[120:135], v[220:223], v[168:171], v[120:135]
    ds_read_b64_tr_b16 v[220:221], v12 offset:24768
    ds_read_b64_tr_b16 v[222:223], v12 offset:26304
    v_mfma_f32_32x32x16_bf16 v[136:151], v[224:227], v[168:171], v[136:151]
    ds_read_b64_tr_b16 v[224:225], v11 offset:24832
    ds_read_b64_tr_b16 v[226:227], v11 offset:26368
    v_mfma_f32_32x32x16_bf16 v[152:167], v[228:231], v[168:171], v[152:167]
    ds_read_b64_tr_b16 v[228:229], v12 offset:24896
    ds_read_b64_tr_b16 v[230:231], v12 offset:26432
    v_mfma_f32_32x32x16_bf16 v[72:87], v[232:235], v[172:175], v[72:87]
    ds_read_b64_tr_b16 v[232:233], v11 offset:30720
    ds_read_b64_tr_b16 v[234:235], v11 offset:32256
    v_mfma_f32_32x32x16_bf16 v[88:103], v[236:239], v[172:175], v[88:103]
    ds_read_b64_tr_b16 v[236:237], v12 offset:30784
    ds_read_b64_tr_b16 v[238:239], v12 offset:32320
    v_mfma_f32_32x32x16_bf16 v[104:119], v[240:243], v[172:175], v[104:119]
    ds_read_b64_tr_b16 v[240:241], v11 offset:30848
    ds_read_b64_tr_b16 v[242:243], v11 offset:32384
    v_mfma_f32_32x32x16_bf16 v[120:135], v[244:247], v[172:175], v[120:135]
    ds_read_b64_tr_b16 v[244:245], v12 offset:30912
    ds_read_b64_tr_b16 v[246:247], v12 offset:32448
    v_mfma_f32_32x32x16_bf16 v[136:151], v[248:251], v[172:175], v[136:151]
    ds_read_b64_tr_b16 v[248:249], v11 offset:30976
    ds_read_b64_tr_b16 v[250:251], v11 offset:32512
    v_mfma_f32_32x32x16_bf16 v[152:167], v[252:255], v[172:175], v[152:167]
    ds_read_b64_tr_b16 v[252:253], v12 offset:31040
    ds_read_b64_tr_b16 v[254:255], v12 offset:32576
    s_waitcnt lgkmcnt(0)
    s_barrier
    ds_read_b128 v[168:171], v20 offset:24576
    ds_read_b128 v[172:175], v21 offset:24576
    v_mfma_f32_32x32x16_bf16 v[72:87], v[208:211], v[176:179], v[72:87]
    ds_read_b64_tr_b16 v[208:209], v11 offset:36864
    ds_read_b64_tr_b16 v[210:211], v11 offset:38400
    v_mfma_f32_32x32x16_bf16 v[88:103], v[212:215], v[176:179], v[88:103]
    ds_read_b64_tr_b16 v[212:213], v12 offset:36928
    ds_read_b64_tr_b16 v[214:215], v12 offset:38464
    v_mfma_f32_32x32x16_bf16 v[104:119], v[216:219], v[176:179], v[104:119]
    ds_read_b64_tr_b16 v[216:217], v11 offset:36992
    ds_read_b64_tr_b16 v[218:219], v11 offset:38528
    v_mfma_f32_32x32x16_bf16 v[120:135], v[220:223], v[176:179], v[120:135]
    ds_read_b64_tr_b16 v[220:221], v12 offset:37056
    ds_read_b64_tr_b16 v[222:223], v12 offset:38592
    v_mfma_f32_32x32x16_bf16 v[136:151], v[224:227], v[176:179], v[136:151]
    ds_read_b64_tr_b16 v[224:225], v11 offset:37120
    ds_read_b64_tr_b16 v[226:227], v11 offset:38656
    v_mfma_f32_32x32x16_bf16 v[152:167], v[228:231], v[176:179], v[152:167]
    ds_read_b64_tr_b16 v[228:229], v12 offset:37184
    ds_read_b64_tr_b16 v[230:231], v12 offset:38720
    v_mfma_f32_32x32x16_bf16 v[72:87], v[232:235], v[180:183], v[72:87]
    ds_read_b64_tr_b16 v[232:233], v11 offset:43008
    ds_read_b64_tr_b16 v[234:235], v11 offset:44544
    v_mfma_f32_32x32x16_bf16 v[88:103], v[236:239], v[180:183], v[88:103]
    ds_read_b64_tr_b16 v[236:237], v12 offset:43072
    ds_read_b64_tr_b16 v[238:239], v12 offset:44608
    v_mfma_f32_32x32x16_bf16 v[104:119], v[240:243], v[180:183], v[104:119]
    ds_read_b64_tr_b16 v[240:241], v11 offset:43136
    ds_read_b64_tr_b16 v[242:243], v11 offset:44672
    v_mfma_f32_32x32x16_bf16 v[120:135], v[244:247], v[180:183], v[120:135]
    ds_read_b64_tr_b16 v[244:245], v12 offset:43200
    ds_read_b64_tr_b16 v[246:247], v12 offset:44736
    v_mfma_f32_32x32x16_bf16 v[136:151], v[248:251], v[180:183], v[136:151]
    ds_read_b64_tr_b16 v[248:249], v11 offset:43264
    ds_read_b64_tr_b16 v[250:251], v11 offset:44800
    v_mfma_f32_32x32x16_bf16 v[152:167], v[252:255], v[180:183], v[152:167]
    ds_read_b64_tr_b16 v[252:253], v12 offset:43328
    ds_read_b64_tr_b16 v[254:255], v12 offset:44864
    s_waitcnt lgkmcnt(0)
    s_barrier
    ds_read_b128 v[176:179], v22 offset:24576
    ds_read_b128 v[180:183], v23 offset:24576
    v_mfma_f32_32x32x16_bf16 v[72:87], v[208:211], v[168:171], v[72:87]
    ds_read_b64_tr_b16 v[208:209], v11 offset:0
    ds_read_b64_tr_b16 v[210:211], v11 offset:1536
    v_mfma_f32_32x32x16_bf16 v[88:103], v[212:215], v[168:171], v[88:103]
    ds_read_b64_tr_b16 v[212:213], v12 offset:64
    ds_read_b64_tr_b16 v[214:215], v12 offset:1600
    v_mfma_f32_32x32x16_bf16 v[104:119], v[216:219], v[168:171], v[104:119]
    ds_read_b64_tr_b16 v[216:217], v11 offset:128
    ds_read_b64_tr_b16 v[218:219], v11 offset:1664
    v_mfma_f32_32x32x16_bf16 v[120:135], v[220:223], v[168:171], v[120:135]
    ds_read_b64_tr_b16 v[220:221], v12 offset:192
    ds_read_b64_tr_b16 v[222:223], v12 offset:1728
    v_mfma_f32_32x32x16_bf16 v[136:151], v[224:227], v[168:171], v[136:151]
    ds_read_b64_tr_b16 v[224:225], v11 offset:256
    ds_read_b64_tr_b16 v[226:227], v11 offset:1792
    v_mfma_f32_32x32x16_bf16 v[152:167], v[228:231], v[168:171], v[152:167]
    ds_read_b64_tr_b16 v[228:229], v12 offset:320
    ds_read_b64_tr_b16 v[230:231], v12 offset:1856
    v_mfma_f32_32x32x16_bf16 v[72:87], v[232:235], v[172:175], v[72:87]
    ds_read_b64_tr_b16 v[232:233], v11 offset:6144
    ds_read_b64_tr_b16 v[234:235], v11 offset:7680
    v_mfma_f32_32x32x16_bf16 v[88:103], v[236:239], v[172:175], v[88:103]
    ds_read_b64_tr_b16 v[236:237], v12 offset:6208
    ds_read_b64_tr_b16 v[238:239], v12 offset:7744
    v_mfma_f32_32x32x16_bf16 v[104:119], v[240:243], v[172:175], v[104:119]
    ds_read_b64_tr_b16 v[240:241], v11 offset:6272
    ds_read_b64_tr_b16 v[242:243], v11 offset:7808
    v_mfma_f32_32x32x16_bf16 v[120:135], v[244:247], v[172:175], v[120:135]
    ds_read_b64_tr_b16 v[244:245], v12 offset:6336
    ds_read_b64_tr_b16 v[246:247], v12 offset:7872
    v_mfma_f32_32x32x16_bf16 v[136:151], v[248:251], v[172:175], v[136:151]
    ds_read_b64_tr_b16 v[248:249], v11 offset:6400
    ds_read_b64_tr_b16 v[250:251], v11 offset:7936
    v_mfma_f32_32x32x16_bf16 v[152:167], v[252:255], v[172:175], v[152:167]
    ds_read_b64_tr_b16 v[252:253], v12 offset:6464
    ds_read_b64_tr_b16 v[254:255], v12 offset:8000
    s_waitcnt lgkmcnt(0)
    s_barrier
    ds_read_b128 v[168:171], v20 offset:0
    ds_read_b128 v[172:175], v21 offset:0
    v_mfma_f32_32x32x16_bf16 v[72:87], v[208:211], v[176:179], v[72:87]
    ds_read_b64_tr_b16 v[208:209], v11 offset:12288
    ds_read_b64_tr_b16 v[210:211], v11 offset:13824
    v_mfma_f32_32x32x16_bf16 v[88:103], v[212:215], v[176:179], v[88:103]
    ds_read_b64_tr_b16 v[212:213], v12 offset:12352
    ds_read_b64_tr_b16 v[214:215], v12 offset:13888
    v_mfma_f32_32x32x16_bf16 v[104:119], v[216:219], v[176:179], v[104:119]
    ds_read_b64_tr_b16 v[216:217], v11 offset:12416
    ds_read_b64_tr_b16 v[218:219], v11 offset:13952
    v_mfma_f32_32x32x16_bf16 v[120:135], v[220:223], v[176:179], v[120:135]
    ds_read_b64_tr_b16 v[220:221], v12 offset:12480
    ds_read_b64_tr_b16 v[222:223], v12 offset:14016
    v_mfma_f32_32x32x16_bf16 v[136:151], v[224:227], v[176:179], v[136:151]
    ds_read_b64_tr_b16 v[224:225], v11 offset:12544
    ds_read_b64_tr_b16 v[226:227], v11 offset:14080
    v_mfma_f32_32x32x16_bf16 v[152:167], v[228:231], v[176:179], v[152:167]
    ds_read_b64_tr_b16 v[228:229], v12 offset:12608
    ds_read_b64_tr_b16 v[230:231], v12 offset:14144
    v_mfma_f32_32x32x16_bf16 v[72:87], v[232:235], v[180:183], v[72:87]
    ds_read_b64_tr_b16 v[232:233], v11 offset:18432
    ds_read_b64_tr_b16 v[234:235], v11 offset:19968
    v_mfma_f32_32x32x16_bf16 v[88:103], v[236:239], v[180:183], v[88:103]
    ds_read_b64_tr_b16 v[236:237], v12 offset:18496
    ds_read_b64_tr_b16 v[238:239], v12 offset:20032
    v_mfma_f32_32x32x16_bf16 v[104:119], v[240:243], v[180:183], v[104:119]
    ds_read_b64_tr_b16 v[240:241], v11 offset:18560
    ds_read_b64_tr_b16 v[242:243], v11 offset:20096
    v_mfma_f32_32x32x16_bf16 v[120:135], v[244:247], v[180:183], v[120:135]
    ds_read_b64_tr_b16 v[244:245], v12 offset:18624
    ds_read_b64_tr_b16 v[246:247], v12 offset:20160
    v_mfma_f32_32x32x16_bf16 v[136:151], v[248:251], v[180:183], v[136:151]
    ds_read_b64_tr_b16 v[248:249], v11 offset:18688
    ds_read_b64_tr_b16 v[250:251], v11 offset:20224
    v_mfma_f32_32x32x16_bf16 v[152:167], v[252:255], v[180:183], v[152:167]
    ds_read_b64_tr_b16 v[252:253], v12 offset:18752
    ds_read_b64_tr_b16 v[254:255], v12 offset:20288
    s_waitcnt lgkmcnt(0)
    s_barrier
    ds_read_b128 v[176:179], v22 offset:0
    ds_read_b128 v[180:183], v23 offset:0
    v_mfma_f32_32x32x16_bf16 v[72:87], v[208:211], v[168:171], v[72:87]
    ds_read_b64_tr_b16 v[208:209], v11 offset:24576
    ds_read_b64_tr_b16 v[210:211], v11 offset:26112
    v_mfma_f32_32x32x16_bf16 v[88:103], v[212:215], v[168:171], v[88:103]
    ds_read_b64_tr_b16 v[212:213], v12 offset:24640
    ds_read_b64_tr_b16 v[214:215], v12 offset:26176
    v_mfma_f32_32x32x16_bf16 v[104:119], v[216:219], v[168:171], v[104:119]
    ds_read_b64_tr_b16 v[216:217], v11 offset:24704
    ds_read_b64_tr_b16 v[218:219], v11 offset:26240
    v_mfma_f32_32x32x16_bf16 v[120:135], v[220:223], v[168:171], v[120:135]
    ds_read_b64_tr_b16 v[220:221], v12 offset:24768
    ds_read_b64_tr_b16 v[222:223], v12 offset:26304
    v_mfma_f32_32x32x16_bf16 v[136:151], v[224:227], v[168:171], v[136:151]
    ds_read_b64_tr_b16 v[224:225], v11 offset:24832
    ds_read_b64_tr_b16 v[226:227], v11 offset:26368
    v_mfma_f32_32x32x16_bf16 v[152:167], v[228:231], v[168:171], v[152:167]
    ds_read_b64_tr_b16 v[228:229], v12 offset:24896
    ds_read_b64_tr_b16 v[230:231], v12 offset:26432
    v_mfma_f32_32x32x16_bf16 v[72:87], v[232:235], v[172:175], v[72:87]
    ds_read_b64_tr_b16 v[232:233], v11 offset:30720
    ds_read_b64_tr_b16 v[234:235], v11 offset:32256
    v_mfma_f32_32x32x16_bf16 v[88:103], v[236:239], v[172:175], v[88:103]
    ds_read_b64_tr_b16 v[236:237], v12 offset:30784
    ds_read_b64_tr_b16 v[238:239], v12 offset:32320
    v_mfma_f32_32x32x16_bf16 v[104:119], v[240:243], v[172:175], v[104:119]
    ds_read_b64_tr_b16 v[240:241], v11 offset:30848
    ds_read_b64_tr_b16 v[242:243], v11 offset:32384
    v_mfma_f32_32x32x16_bf16 v[120:135], v[244:247], v[172:175], v[120:135]
    ds_read_b64_tr_b16 v[244:245], v12 offset:30912
    ds_read_b64_tr_b16 v[246:247], v12 offset:32448
    v_mfma_f32_32x32x16_bf16 v[136:151], v[248:251], v[172:175], v[136:151]
    ds_read_b64_tr_b16 v[248:249], v11 offset:30976
    ds_read_b64_tr_b16 v[250:251], v11 offset:32512
    v_mfma_f32_32x32x16_bf16 v[152:167], v[252:255], v[172:175], v[152:167]
    ds_read_b64_tr_b16 v[252:253], v12 offset:31040
    ds_read_b64_tr_b16 v[254:255], v12 offset:32576
    s_waitcnt lgkmcnt(0)
    s_barrier
    ds_read_b128 v[168:171], v20 offset:24576
    ds_read_b128 v[172:175], v21 offset:24576
    v_mfma_f32_32x32x16_bf16 v[72:87], v[208:211], v[176:179], v[72:87]
    ds_read_b64_tr_b16 v[208:209], v11 offset:36864
    ds_read_b64_tr_b16 v[210:211], v11 offset:38400
    v_mfma_f32_32x32x16_bf16 v[88:103], v[212:215], v[176:179], v[88:103]
    ds_read_b64_tr_b16 v[212:213], v12 offset:36928
    ds_read_b64_tr_b16 v[214:215], v12 offset:38464
    v_mfma_f32_32x32x16_bf16 v[104:119], v[216:219], v[176:179], v[104:119]
    ds_read_b64_tr_b16 v[216:217], v11 offset:36992
    ds_read_b64_tr_b16 v[218:219], v11 offset:38528
    v_mfma_f32_32x32x16_bf16 v[120:135], v[220:223], v[176:179], v[120:135]
    ds_read_b64_tr_b16 v[220:221], v12 offset:37056
    ds_read_b64_tr_b16 v[222:223], v12 offset:38592
    v_mfma_f32_32x32x16_bf16 v[136:151], v[224:227], v[176:179], v[136:151]
    ds_read_b64_tr_b16 v[224:225], v11 offset:37120
    ds_read_b64_tr_b16 v[226:227], v11 offset:38656
    v_mfma_f32_32x32x16_bf16 v[152:167], v[228:231], v[176:179], v[152:167]
    ds_read_b64_tr_b16 v[228:229], v12 offset:37184
    ds_read_b64_tr_b16 v[230:231], v12 offset:38720
    v_mfma_f32_32x32x16_bf16 v[72:87], v[232:235], v[180:183], v[72:87]
    ds_read_b64_tr_b16 v[232:233], v11 offset:43008
    ds_read_b64_tr_b16 v[234:235], v11 offset:44544
    v_mfma_f32_32x32x16_bf16 v[88:103], v[236:239], v[180:183], v[88:103]
    ds_read_b64_tr_b16 v[236:237], v12 offset:43072
    ds_read_b64_tr_b16 v[238:239], v12 offset:44608
    v_mfma_f32_32x32x16_bf16 v[104:119], v[240:243], v[180:183], v[104:119]
    ds_read_b64_tr_b16 v[240:241], v11 offset:43136
    ds_read_b64_tr_b16 v[242:243], v11 offset:44672
    v_mfma_f32_32x32x16_bf16 v[120:135], v[244:247], v[180:183], v[120:135]
    ds_read_b64_tr_b16 v[244:245], v12 offset:43200
    ds_read_b64_tr_b16 v[246:247], v12 offset:44736
    v_mfma_f32_32x32x16_bf16 v[136:151], v[248:251], v[180:183], v[136:151]
    ds_read_b64_tr_b16 v[248:249], v11 offset:43264
    ds_read_b64_tr_b16 v[250:251], v11 offset:44800
    v_mfma_f32_32x32x16_bf16 v[152:167], v[252:255], v[180:183], v[152:167]
    ds_read_b64_tr_b16 v[252:253], v12 offset:43328
    ds_read_b64_tr_b16 v[254:255], v12 offset:44864
    s_waitcnt lgkmcnt(0)
    s_barrier
    ds_read_b128 v[176:179], v22 offset:24576
    ds_read_b128 v[180:183], v23 offset:24576
    v_mfma_f32_32x32x16_bf16 v[72:87], v[208:211], v[168:171], v[72:87]
    ds_read_b64_tr_b16 v[208:209], v11 offset:0
    ds_read_b64_tr_b16 v[210:211], v11 offset:1536
    v_mfma_f32_32x32x16_bf16 v[88:103], v[212:215], v[168:171], v[88:103]
    ds_read_b64_tr_b16 v[212:213], v12 offset:64
    ds_read_b64_tr_b16 v[214:215], v12 offset:1600
    v_mfma_f32_32x32x16_bf16 v[104:119], v[216:219], v[168:171], v[104:119]
    ds_read_b64_tr_b16 v[216:217], v11 offset:128
    ds_read_b64_tr_b16 v[218:219], v11 offset:1664
    v_mfma_f32_32x32x16_bf16 v[120:135], v[220:223], v[168:171], v[120:135]
    ds_read_b64_tr_b16 v[220:221], v12 offset:192
    ds_read_b64_tr_b16 v[222:223], v12 offset:1728
    v_mfma_f32_32x32x16_bf16 v[136:151], v[224:227], v[168:171], v[136:151]
    ds_read_b64_tr_b16 v[224:225], v11 offset:256
    ds_read_b64_tr_b16 v[226:227], v11 offset:1792
    v_mfma_f32_32x32x16_bf16 v[152:167], v[228:231], v[168:171], v[152:167]
    ds_read_b64_tr_b16 v[228:229], v12 offset:320
    ds_read_b64_tr_b16 v[230:231], v12 offset:1856
    v_mfma_f32_32x32x16_bf16 v[72:87], v[232:235], v[172:175], v[72:87]
    ds_read_b64_tr_b16 v[232:233], v11 offset:6144
    ds_read_b64_tr_b16 v[234:235], v11 offset:7680
    v_mfma_f32_32x32x16_bf16 v[88:103], v[236:239], v[172:175], v[88:103]
    ds_read_b64_tr_b16 v[236:237], v12 offset:6208
    ds_read_b64_tr_b16 v[238:239], v12 offset:7744
    v_mfma_f32_32x32x16_bf16 v[104:119], v[240:243], v[172:175], v[104:119]
    ds_read_b64_tr_b16 v[240:241], v11 offset:6272
    ds_read_b64_tr_b16 v[242:243], v11 offset:7808
    v_mfma_f32_32x32x16_bf16 v[120:135], v[244:247], v[172:175], v[120:135]
    ds_read_b64_tr_b16 v[244:245], v12 offset:6336
    ds_read_b64_tr_b16 v[246:247], v12 offset:7872
    v_mfma_f32_32x32x16_bf16 v[136:151], v[248:251], v[172:175], v[136:151]
    ds_read_b64_tr_b16 v[248:249], v11 offset:6400
    ds_read_b64_tr_b16 v[250:251], v11 offset:7936
    v_mfma_f32_32x32x16_bf16 v[152:167], v[252:255], v[172:175], v[152:167]
    ds_read_b64_tr_b16 v[252:253], v12 offset:6464
    ds_read_b64_tr_b16 v[254:255], v12 offset:8000
    s_waitcnt lgkmcnt(0)
    s_barrier
    ds_read_b128 v[168:171], v20 offset:0
    ds_read_b128 v[172:175], v21 offset:0
    v_mfma_f32_32x32x16_bf16 v[72:87], v[208:211], v[176:179], v[72:87]
    ds_read_b64_tr_b16 v[208:209], v11 offset:12288
    ds_read_b64_tr_b16 v[210:211], v11 offset:13824
    v_mfma_f32_32x32x16_bf16 v[88:103], v[212:215], v[176:179], v[88:103]
    ds_read_b64_tr_b16 v[212:213], v12 offset:12352
    ds_read_b64_tr_b16 v[214:215], v12 offset:13888
    v_mfma_f32_32x32x16_bf16 v[104:119], v[216:219], v[176:179], v[104:119]
    ds_read_b64_tr_b16 v[216:217], v11 offset:12416
    ds_read_b64_tr_b16 v[218:219], v11 offset:13952
    v_mfma_f32_32x32x16_bf16 v[120:135], v[220:223], v[176:179], v[120:135]
    ds_read_b64_tr_b16 v[220:221], v12 offset:12480
    ds_read_b64_tr_b16 v[222:223], v12 offset:14016
    v_mfma_f32_32x32x16_bf16 v[136:151], v[224:227], v[176:179], v[136:151]
    ds_read_b64_tr_b16 v[224:225], v11 offset:12544
    ds_read_b64_tr_b16 v[226:227], v11 offset:14080
    v_mfma_f32_32x32x16_bf16 v[152:167], v[228:231], v[176:179], v[152:167]
    ds_read_b64_tr_b16 v[228:229], v12 offset:12608
    ds_read_b64_tr_b16 v[230:231], v12 offset:14144
    v_mfma_f32_32x32x16_bf16 v[72:87], v[232:235], v[180:183], v[72:87]
    ds_read_b64_tr_b16 v[232:233], v11 offset:18432
    ds_read_b64_tr_b16 v[234:235], v11 offset:19968
    v_mfma_f32_32x32x16_bf16 v[88:103], v[236:239], v[180:183], v[88:103]
    ds_read_b64_tr_b16 v[236:237], v12 offset:18496
    ds_read_b64_tr_b16 v[238:239], v12 offset:20032
    v_mfma_f32_32x32x16_bf16 v[104:119], v[240:243], v[180:183], v[104:119]
    ds_read_b64_tr_b16 v[240:241], v11 offset:18560
    ds_read_b64_tr_b16 v[242:243], v11 offset:20096
    v_mfma_f32_32x32x16_bf16 v[120:135], v[244:247], v[180:183], v[120:135]
    ds_read_b64_tr_b16 v[244:245], v12 offset:18624
    ds_read_b64_tr_b16 v[246:247], v12 offset:20160
    v_mfma_f32_32x32x16_bf16 v[136:151], v[248:251], v[180:183], v[136:151]
    ds_read_b64_tr_b16 v[248:249], v11 offset:18688
    ds_read_b64_tr_b16 v[250:251], v11 offset:20224
    v_mfma_f32_32x32x16_bf16 v[152:167], v[252:255], v[180:183], v[152:167]
    ds_read_b64_tr_b16 v[252:253], v12 offset:18752
    ds_read_b64_tr_b16 v[254:255], v12 offset:20288
    s_waitcnt lgkmcnt(0)
    s_barrier
    ds_read_b128 v[176:179], v22 offset:0
    ds_read_b128 v[180:183], v23 offset:0
    v_mfma_f32_32x32x16_bf16 v[72:87], v[208:211], v[168:171], v[72:87]
    ds_read_b64_tr_b16 v[208:209], v11 offset:24576
    ds_read_b64_tr_b16 v[210:211], v11 offset:26112
    v_mfma_f32_32x32x16_bf16 v[88:103], v[212:215], v[168:171], v[88:103]
    ds_read_b64_tr_b16 v[212:213], v12 offset:24640
    ds_read_b64_tr_b16 v[214:215], v12 offset:26176
    v_mfma_f32_32x32x16_bf16 v[104:119], v[216:219], v[168:171], v[104:119]
    ds_read_b64_tr_b16 v[216:217], v11 offset:24704
    ds_read_b64_tr_b16 v[218:219], v11 offset:26240
    v_mfma_f32_32x32x16_bf16 v[120:135], v[220:223], v[168:171], v[120:135]
    ds_read_b64_tr_b16 v[220:221], v12 offset:24768
    ds_read_b64_tr_b16 v[222:223], v12 offset:26304
    v_mfma_f32_32x32x16_bf16 v[136:151], v[224:227], v[168:171], v[136:151]
    ds_read_b64_tr_b16 v[224:225], v11 offset:24832
    ds_read_b64_tr_b16 v[226:227], v11 offset:26368
    v_mfma_f32_32x32x16_bf16 v[152:167], v[228:231], v[168:171], v[152:167]
    ds_read_b64_tr_b16 v[228:229], v12 offset:24896
    ds_read_b64_tr_b16 v[230:231], v12 offset:26432
    v_mfma_f32_32x32x16_bf16 v[72:87], v[232:235], v[172:175], v[72:87]
    ds_read_b64_tr_b16 v[232:233], v11 offset:30720
    ds_read_b64_tr_b16 v[234:235], v11 offset:32256
    v_mfma_f32_32x32x16_bf16 v[88:103], v[236:239], v[172:175], v[88:103]
    ds_read_b64_tr_b16 v[236:237], v12 offset:30784
    ds_read_b64_tr_b16 v[238:239], v12 offset:32320
    v_mfma_f32_32x32x16_bf16 v[104:119], v[240:243], v[172:175], v[104:119]
    ds_read_b64_tr_b16 v[240:241], v11 offset:30848
    ds_read_b64_tr_b16 v[242:243], v11 offset:32384
    v_mfma_f32_32x32x16_bf16 v[120:135], v[244:247], v[172:175], v[120:135]
    ds_read_b64_tr_b16 v[244:245], v12 offset:30912
    ds_read_b64_tr_b16 v[246:247], v12 offset:32448
    v_mfma_f32_32x32x16_bf16 v[136:151], v[248:251], v[172:175], v[136:151]
    ds_read_b64_tr_b16 v[248:249], v11 offset:30976
    ds_read_b64_tr_b16 v[250:251], v11 offset:32512
    v_mfma_f32_32x32x16_bf16 v[152:167], v[252:255], v[172:175], v[152:167]
    ds_read_b64_tr_b16 v[252:253], v12 offset:31040
    ds_read_b64_tr_b16 v[254:255], v12 offset:32576
    s_waitcnt lgkmcnt(0)
    s_barrier
    ds_read_b128 v[168:171], v20 offset:24576
    ds_read_b128 v[172:175], v21 offset:24576
    v_mfma_f32_32x32x16_bf16 v[72:87], v[208:211], v[176:179], v[72:87]
    ds_read_b64_tr_b16 v[208:209], v11 offset:36864
    ds_read_b64_tr_b16 v[210:211], v11 offset:38400
    v_mfma_f32_32x32x16_bf16 v[88:103], v[212:215], v[176:179], v[88:103]
    ds_read_b64_tr_b16 v[212:213], v12 offset:36928
    ds_read_b64_tr_b16 v[214:215], v12 offset:38464
    v_mfma_f32_32x32x16_bf16 v[104:119], v[216:219], v[176:179], v[104:119]
    ds_read_b64_tr_b16 v[216:217], v11 offset:36992
    ds_read_b64_tr_b16 v[218:219], v11 offset:38528
    v_mfma_f32_32x32x16_bf16 v[120:135], v[220:223], v[176:179], v[120:135]
    ds_read_b64_tr_b16 v[220:221], v12 offset:37056
    ds_read_b64_tr_b16 v[222:223], v12 offset:38592
    v_mfma_f32_32x32x16_bf16 v[136:151], v[224:227], v[176:179], v[136:151]
    ds_read_b64_tr_b16 v[224:225], v11 offset:37120
    ds_read_b64_tr_b16 v[226:227], v11 offset:38656
    v_mfma_f32_32x32x16_bf16 v[152:167], v[228:231], v[176:179], v[152:167]
    ds_read_b64_tr_b16 v[228:229], v12 offset:37184
    ds_read_b64_tr_b16 v[230:231], v12 offset:38720
    v_mfma_f32_32x32x16_bf16 v[72:87], v[232:235], v[180:183], v[72:87]
    ds_read_b64_tr_b16 v[232:233], v11 offset:43008
    ds_read_b64_tr_b16 v[234:235], v11 offset:44544
    v_mfma_f32_32x32x16_bf16 v[88:103], v[236:239], v[180:183], v[88:103]
    ds_read_b64_tr_b16 v[236:237], v12 offset:43072
    ds_read_b64_tr_b16 v[238:239], v12 offset:44608
    v_mfma_f32_32x32x16_bf16 v[104:119], v[240:243], v[180:183], v[104:119]
    ds_read_b64_tr_b16 v[240:241], v11 offset:43136
    ds_read_b64_tr_b16 v[242:243], v11 offset:44672
    v_mfma_f32_32x32x16_bf16 v[120:135], v[244:247], v[180:183], v[120:135]
    ds_read_b64_tr_b16 v[244:245], v12 offset:43200
    ds_read_b64_tr_b16 v[246:247], v12 offset:44736
    v_mfma_f32_32x32x16_bf16 v[136:151], v[248:251], v[180:183], v[136:151]
    ds_read_b64_tr_b16 v[248:249], v11 offset:43264
    ds_read_b64_tr_b16 v[250:251], v11 offset:44800
    v_mfma_f32_32x32x16_bf16 v[152:167], v[252:255], v[180:183], v[152:167]
    ds_read_b64_tr_b16 v[252:253], v12 offset:43328
    ds_read_b64_tr_b16 v[254:255], v12 offset:44864
    s_waitcnt lgkmcnt(0)
    s_barrier
    ds_read_b128 v[176:179], v22 offset:24576
    ds_read_b128 v[180:183], v23 offset:24576
    v_mfma_f32_32x32x16_bf16 v[72:87], v[208:211], v[168:171], v[72:87]
    ds_read_b64_tr_b16 v[208:209], v11 offset:0
    ds_read_b64_tr_b16 v[210:211], v11 offset:1536
    v_mfma_f32_32x32x16_bf16 v[88:103], v[212:215], v[168:171], v[88:103]
    ds_read_b64_tr_b16 v[212:213], v12 offset:64
    ds_read_b64_tr_b16 v[214:215], v12 offset:1600
    v_mfma_f32_32x32x16_bf16 v[104:119], v[216:219], v[168:171], v[104:119]
    ds_read_b64_tr_b16 v[216:217], v11 offset:128
    ds_read_b64_tr_b16 v[218:219], v11 offset:1664
    v_mfma_f32_32x32x16_bf16 v[120:135], v[220:223], v[168:171], v[120:135]
    ds_read_b64_tr_b16 v[220:221], v12 offset:192
    ds_read_b64_tr_b16 v[222:223], v12 offset:1728
    v_mfma_f32_32x32x16_bf16 v[136:151], v[224:227], v[168:171], v[136:151]
    ds_read_b64_tr_b16 v[224:225], v11 offset:256
    ds_read_b64_tr_b16 v[226:227], v11 offset:1792
    v_mfma_f32_32x32x16_bf16 v[152:167], v[228:231], v[168:171], v[152:167]
    ds_read_b64_tr_b16 v[228:229], v12 offset:320
    ds_read_b64_tr_b16 v[230:231], v12 offset:1856
    v_mfma_f32_32x32x16_bf16 v[72:87], v[232:235], v[172:175], v[72:87]
    ds_read_b64_tr_b16 v[232:233], v11 offset:6144
    ds_read_b64_tr_b16 v[234:235], v11 offset:7680
    v_mfma_f32_32x32x16_bf16 v[88:103], v[236:239], v[172:175], v[88:103]
    ds_read_b64_tr_b16 v[236:237], v12 offset:6208
    ds_read_b64_tr_b16 v[238:239], v12 offset:7744
    v_mfma_f32_32x32x16_bf16 v[104:119], v[240:243], v[172:175], v[104:119]
    ds_read_b64_tr_b16 v[240:241], v11 offset:6272
    ds_read_b64_tr_b16 v[242:243], v11 offset:7808
    v_mfma_f32_32x32x16_bf16 v[120:135], v[244:247], v[172:175], v[120:135]
    ds_read_b64_tr_b16 v[244:245], v12 offset:6336
    ds_read_b64_tr_b16 v[246:247], v12 offset:7872
    v_mfma_f32_32x32x16_bf16 v[136:151], v[248:251], v[172:175], v[136:151]
    ds_read_b64_tr_b16 v[248:249], v11 offset:6400
    ds_read_b64_tr_b16 v[250:251], v11 offset:7936
    v_mfma_f32_32x32x16_bf16 v[152:167], v[252:255], v[172:175], v[152:167]
    ds_read_b64_tr_b16 v[252:253], v12 offset:6464
    ds_read_b64_tr_b16 v[254:255], v12 offset:8000
    s_waitcnt lgkmcnt(0)
    s_barrier
    v_mfma_f32_32x32x16_bf16 v[72:87], v[208:211], v[176:179], v[72:87]
    v_mfma_f32_32x32x16_bf16 v[88:103], v[212:215], v[176:179], v[88:103]
    v_mfma_f32_32x32x16_bf16 v[104:119], v[216:219], v[176:179], v[104:119]
    v_mfma_f32_32x32x16_bf16 v[120:135], v[220:223], v[176:179], v[120:135]
    v_mfma_f32_32x32x16_bf16 v[136:151], v[224:227], v[176:179], v[136:151]
    v_mfma_f32_32x32x16_bf16 v[152:167], v[228:231], v[176:179], v[152:167]
    v_mfma_f32_32x32x16_bf16 v[72:87], v[232:235], v[180:183], v[72:87]
    v_mfma_f32_32x32x16_bf16 v[88:103], v[236:239], v[180:183], v[88:103]
    v_mfma_f32_32x32x16_bf16 v[104:119], v[240:243], v[180:183], v[104:119]
    v_mfma_f32_32x32x16_bf16 v[120:135], v[244:247], v[180:183], v[120:135]
    v_mfma_f32_32x32x16_bf16 v[136:151], v[248:251], v[180:183], v[136:151]
    v_mfma_f32_32x32x16_bf16 v[152:167], v[252:255], v[180:183], v[152:167]
    s_nop 15
    v_cvt_pk_bf16_f32 v24, v72, v73
    v_cvt_pk_bf16_f32 v25, v74, v75
    v_cvt_pk_bf16_f32 v26, v76, v77
    v_cvt_pk_bf16_f32 v27, v78, v79
    v_cvt_pk_bf16_f32 v28, v80, v81
    v_cvt_pk_bf16_f32 v29, v82, v83
    v_cvt_pk_bf16_f32 v30, v84, v85
    v_cvt_pk_bf16_f32 v31, v86, v87
    v_cvt_pk_bf16_f32 v32, v88, v89
    v_cvt_pk_bf16_f32 v33, v90, v91
    v_cvt_pk_bf16_f32 v34, v92, v93
    v_cvt_pk_bf16_f32 v35, v94, v95
    v_cvt_pk_bf16_f32 v36, v96, v97
    v_cvt_pk_bf16_f32 v37, v98, v99
    v_cvt_pk_bf16_f32 v38, v100, v101
    v_cvt_pk_bf16_f32 v39, v102, v103
    v_cvt_pk_bf16_f32 v40, v104, v105
    v_cvt_pk_bf16_f32 v41, v106, v107
    v_cvt_pk_bf16_f32 v42, v108, v109
    v_cvt_pk_bf16_f32 v43, v110, v111
    v_cvt_pk_bf16_f32 v44, v112, v113
    v_cvt_pk_bf16_f32 v45, v114, v115
    v_cvt_pk_bf16_f32 v46, v116, v117
    v_cvt_pk_bf16_f32 v47, v118, v119
    v_cvt_pk_bf16_f32 v48, v120, v121
    v_cvt_pk_bf16_f32 v49, v122, v123
    v_cvt_pk_bf16_f32 v50, v124, v125
    v_cvt_pk_bf16_f32 v51, v126, v127
    v_cvt_pk_bf16_f32 v52, v128, v129
    v_cvt_pk_bf16_f32 v53, v130, v131
    v_cvt_pk_bf16_f32 v54, v132, v133
    v_cvt_pk_bf16_f32 v55, v134, v135
    v_cvt_pk_bf16_f32 v56, v136, v137
    v_cvt_pk_bf16_f32 v57, v138, v139
    v_cvt_pk_bf16_f32 v58, v140, v141
    v_cvt_pk_bf16_f32 v59, v142, v143
    v_cvt_pk_bf16_f32 v60, v144, v145
    v_cvt_pk_bf16_f32 v61, v146, v147
    v_cvt_pk_bf16_f32 v62, v148, v149
    v_cvt_pk_bf16_f32 v63, v150, v151
    v_cvt_pk_bf16_f32 v64, v152, v153
    v_cvt_pk_bf16_f32 v65, v154, v155
    v_cvt_pk_bf16_f32 v66, v156, v157
    v_cvt_pk_bf16_f32 v67, v158, v159
    v_cvt_pk_bf16_f32 v68, v160, v161
    v_cvt_pk_bf16_f32 v69, v162, v163
    v_cvt_pk_bf16_f32 v70, v164, v165
    v_cvt_pk_bf16_f32 v71, v166, v167
    s_cmp_lt_u32 s3, 4
    s_cbranch_scc1 A_att
    ds_write_b128 v1, v[24:27] offset:0
    ds_write_b128 v1, v[28:31] offset:1024
    ds_write_b128 v1, v[32:35] offset:2048
    ds_write_b128 v1, v[36:39] offset:3072
    ds_write_b128 v1, v[40:43] offset:4096
    ds_write_b128 v1, v[44:47] offset:5120
    ds_write_b128 v1, v[48:51] offset:6144
    ds_write_b128 v1, v[52:55] offset:7168
    ds_write_b128 v1, v[56:59] offset:8192
    ds_write_b128 v1, v[60:63] offset:9216
    ds_write_b128 v1, v[64:67] offset:10240
    ds_write_b128 v1, v[68:71] offset:11264
    s_load_dwordx2 s[40:41], s[0:1], 32
    s_mul_i32 s7, s2, 30720
    s_mul_i32 s35, s9, 10240
    s_add_u32 s7, s7, s35
    v_lshlrev_b32 v16, 7, v0
    v_add_u32 v17, 8192, v16
    v_cmp_gt_u32 vcc, 16, v0
    s_waitcnt lgkmcnt(0)
    s_mov_b32 s40, s40
    s_and_b32 s41, s41, 0xffff
    s_mov_b32 s42, 7864320
    s_mov_b32 s43, 0x00020000
    buffer_load_dword v18, v16, s[40:43], s7 offen
    s_and_saveexec_b64 s[44:45], vcc
    buffer_load_dword v19, v17, s[40:43], s7 offen
    s_endpgm
A_att:
    s_setprio 2
    s_mov_b32 s32, 0x3dd53b95
    s_mov_b32 s46, 0x4299ac27
    s_mov_b32 s33, 0
    s_mov_b32 s49, 0
A_item:
    v_mov_b32 v72, 0
    v_mov_b32 v73, 0
    v_mov_b32 v74, 0
    v_mov_b32 v75, 0
    v_mov_b32 v76, 0
    v_mov_b32 v77, 0
    v_mov_b32 v78, 0
    v_mov_b32 v79, 0
    v_mov_b32 v80, 0
    v_mov_b32 v81, 0
    v_mov_b32 v82, 0
    v_mov_b32 v83, 0
    v_mov_b32 v84, 0
    v_mov_b32 v85, 0
    v_mov_b32 v86, 0
    v_mov_b32 v87, 0
    v_mov_b32 v88, 0
    v_mov_b32 v89, 0
    v_mov_b32 v90, 0
    v_mov_b32 v91, 0
    v_mov_b32 v92, 0
    v_mov_b32 v93, 0
    v_mov_b32 v94, 0
    v_mov_b32 v95, 0
    v_mov_b32 v96, 0
    v_mov_b32 v97, 0
    v_mov_b32 v98, 0
    v_mov_b32 v99, 0
    v_mov_b32 v100, 0
    v_mov_b32 v101, 0
    v_mov_b32 v102, 0
    v_mov_b32 v103, 0
    v_mov_b32 v104, 0
    v_mov_b32 v105, 0
    v_mov_b32 v106, 0
    v_mov_b32 v107, 0
    v_mov_b32 v108, 0
    v_mov_b32 v109, 0
    v_mov_b32 v110, 0
    v_mov_b32 v111, 0
    v_mov_b32 v112, 0
    v_mov_b32 v113, 0
    v_mov_b32 v114, 0
    v_mov_b32 v115, 0
    v_mov_b32 v116, 0
    v_mov_b32 v117, 0
    v_mov_b32 v118, 0
    v_mov_b32 v119, 0
    v_mov_b32 v120, 0
    v_mov_b32 v121, 0
    v_mov_b32 v122, 0
    v_mov_b32 v123, 0
    v_mov_b32 v124, 0
    v_mov_b32 v125, 0
    v_mov_b32 v126, 0
    v_mov_b32 v127, 0
    v_mov_b32 v128, 0
    v_mov_b32 v129, 0
    v_mov_b32 v130, 0
    v_mov_b32 v131, 0
    v_mov_b32 v132, 0
    v_mov_b32 v133, 0
    v_mov_b32 v134, 0
    v_mov_b32 v135, 0
    v_mov_b32 v136, 0
    v_mov_b32 v137, 0
    v_mov_b32 v138, 0
    v_mov_b32 v139, 0
    v_mov_b32 v140, 0
    v_mov_b32 v141, 0
    v_mov_b32 v142, 0
    v_mov_b32 v143, 0
    v_mov_b32 v144, 0
    v_mov_b32 v145, 0
    v_mov_b32 v146, 0
    v_mov_b32 v147, 0
    v_mov_b32 v148, 0
    v_mov_b32 v149, 0
    v_mov_b32 v150, 0
    v_mov_b32 v151, 0
    v_mov_b32 v152, 0
    v_mov_b32 v153, 0
    v_mov_b32 v154, 0
    v_mov_b32 v155, 0
    v_mov_b32 v156, 0
    v_mov_b32 v157, 0
    v_mov_b32 v158, 0
    v_mov_b32 v159, 0
    v_mov_b32 v160, 0
    v_mov_b32 v161, 0
    v_mov_b32 v162, 0
    v_mov_b32 v163, 0
    v_mov_b32 v164, 0
    v_mov_b32 v165, 0
    v_mov_b32 v166, 0
    v_mov_b32 v167, 0
    v_mov_b32 v16, 0xff800000
    v_mov_b32 v17, 0
    s_mov_b32 s47, 0
    v_add_u32 v10, s33, v4
    v_add_u32 v11, s33, v5
    v_add_u32 v12, s33, v6
    v_add_u32 v13, s33, v7
    s_add_u32 s33, s33, 12288
    s_cmp_eq_u32 s33, 122880
    s_cselect_b32 s33, 0, s33
    s_waitcnt lgkmcnt(0)
    s_barrier
    ds_read_b128 v[208:211], v10 offset:0
    ds_read_b128 v[212:215], v11 offset:0
    ds_read_b128 v[216:219], v12 offset:0
    ds_read_b128 v[220:223], v13 offset:0
    ds_read_b128 v[224:227], v10 offset:128
    ds_read_b128 v[228:231], v11 offset:128
    ds_read_b128 v[232:235], v12 offset:128
    ds_read_b128 v[236:239], v13 offset:128
    ds_read_b128 v[240:243], v10 offset:256
    ds_read_b128 v[244:247], v11 offset:256
    ds_read_b128 v[248:251], v12 offset:256
    ds_read_b128 v[252:255], v13 offset:256
    s_waitcnt lgkmcnt(11)
    v_mfma_f32_32x32x16_bf16 v[168:183], v[208:211], v[24:27], 0
    s_waitcnt lgkmcnt(10)
    v_mfma_f32_32x32x16_bf16 v[168:183], v[212:215], v[28:31], v[168:183]
    s_waitcnt lgkmcnt(9)
    v_mfma_f32_32x32x16_bf16 v[168:183], v[216:219], v[32:35], v[168:183]
    s_waitcnt lgkmcnt(8)
    v_mfma_f32_32x32x16_bf16 v[168:183], v[220:223], v[36:39], v[168:183]
    s_waitcnt lgkmcnt(7)
    v_mfma_f32_32x32x16_bf16 v[168:183], v[224:227], v[40:43], v[168:183]
    s_waitcnt lgkmcnt(6)
    v_mfma_f32_32x32x16_bf16 v[168:183], v[228:231], v[44:47], v[168:183]
    s_waitcnt lgkmcnt(5)
    v_mfma_f32_32x32x16_bf16 v[168:183], v[232:235], v[48:51], v[168:183]
    s_waitcnt lgkmcnt(4)
    v_mfma_f32_32x32x16_bf16 v[168:183], v[236:239], v[52:55], v[168:183]
    s_waitcnt lgkmcnt(3)
    v_mfma_f32_32x32x16_bf16 v[168:183], v[240:243], v[56:59], v[168:183]
    s_waitcnt lgkmcnt(2)
    v_mfma_f32_32x32x16_bf16 v[168:183], v[244:247], v[60:63], v[168:183]
    s_waitcnt lgkmcnt(1)
    v_mfma_f32_32x32x16_bf16 v[168:183], v[248:251], v[64:67], v[168:183]
    s_waitcnt lgkmcnt(0)
    v_mfma_f32_32x32x16_bf16 v[168:183], v[252:255], v[68:71], v[168:183]
    v_add_u32 v10, s33, v4
    v_add_u32 v11, s33, v5
    v_add_u32 v12, s33, v6
    v_add_u32 v13, s33, v7
    s_add_u32 s33, s33, 12288
    s_cmp_eq_u32 s33, 122880
    s_cselect_b32 s33, 0, s33
    s_barrier
    ds_read_b128 v[208:211], v10 offset:0
    ds_read_b128 v[212:215], v11 offset:0
    ds_read_b128 v[216:219], v12 offset:0
    ds_read_b128 v[220:223], v13 offset:0
    ds_read_b128 v[224:227], v10 offset:128
    ds_read_b128 v[228:231], v11 offset:128
    s_nop 4
    v_max3_f32 v20, v168, v169, v16
    v_max3_f32 v20, v170, v171, v20
    v_max3_f32 v20, v172, v173, v20
    v_max3_f32 v20, v174, v175, v20
    v_max3_f32 v20, v176, v177, v20
    v_max3_f32 v20, v178, v179, v20
    v_max3_f32 v20, v180, v181, v20
    v_max3_f32 v20, v182, v183, v20
    v_mov_b32 v21, v20
    s_nop 1
    v_permlane32_swap_b32 v20, v21
    v_max_f32 v20, v20, v21
    v_sub_f32 v21, v20, v16
    v_cmp_lt_f32 vcc, s46, v21
    s_cbranch_vccnz A_rare1_p
A_back1_p:
    v_fma_f32 v168, v168, s32, -v18
    v_fma_f32 v169, v169, s32, -v18
    v_fma_f32 v170, v170, s32, -v18
    v_fma_f32 v171, v171, s32, -v18
    v_fma_f32 v172, v172, s32, -v18
    v_fma_f32 v173, v173, s32, -v18
    v_fma_f32 v174, v174, s32, -v18
    v_fma_f32 v175, v175, s32, -v18
    v_fma_f32 v176, v176, s32, -v18
    v_fma_f32 v177, v177, s32, -v18
    v_fma_f32 v178, v178, s32, -v18
    v_fma_f32 v179, v179, s32, -v18
    v_fma_f32 v180, v180, s32, -v18
    v_fma_f32 v181, v181, s32, -v18
    v_fma_f32 v182, v182, s32, -v18
    v_fma_f32 v183, v183, s32, -v18
    v_exp_f32 v168, v168
    v_exp_f32 v169, v169
    v_exp_f32 v170, v170
    s_mov_b32 s34, 0
A_loop:
    s_cmp_lg_u32 s47, 0
    s_cbranch_scc1 A_rare2_e
A_back2_e:
    s_waitcnt lgkmcnt(4)
    v_mfma_f32_32x32x16_bf16 v[184:199], v[208:211], v[24:27], 0
    v_exp_f32 v171, v171
    v_exp_f32 v172, v172
    v_mfma_f32_32x32x16_bf16 v[184:199], v[212:215], v[28:31], v[184:199]
    ds_read_b128 v[208:211], v12 offset:128
    ds_read_b128 v[212:215], v13 offset:128
    v_exp_f32 v173, v173
    v_exp_f32 v174, v174
    s_waitcnt lgkmcnt(4)
    v_mfma_f32_32x32x16_bf16 v[184:199], v[216:219], v[32:35], v[184:199]
    v_exp_f32 v175, v175
    v_exp_f32 v176, v176
    v_mfma_f32_32x32x16_bf16 v[184:199], v[220:223], v[36:39], v[184:199]
    ds_read_b128 v[216:219], v10 offset:256
    ds_read_b128 v[220:223], v11 offset:256
    v_exp_f32 v177, v177
    v_exp_f32 v178, v178
    s_waitcnt lgkmcnt(4)
    v_mfma_f32_32x32x16_bf16 v[184:199], v[224:227], v[40:43], v[184:199]
    v_exp_f32 v179, v179
    v_exp_f32 v180, v180
    v_mfma_f32_32x32x16_bf16 v[184:199], v[228:231], v[44:47], v[184:199]
    ds_read_b128 v[224:227], v12 offset:256
    ds_read_b128 v[228:231], v13 offset:256
    v_exp_f32 v181, v181
    v_exp_f32 v182, v182
    s_waitcnt lgkmcnt(4)
    v_mfma_f32_32x32x16_bf16 v[184:199], v[208:211], v[48:51], v[184:199]
    v_add_u32 v14, s33, v8
    v_add_u32 v15, s33, v9
    s_add_u32 s33, s33, 12288
    s_cmp_eq_u32 s33, 122880
    s_cselect_b32 s33, 0, s33
    v_exp_f32 v183, v183
    v_mfma_f32_32x32x16_bf16 v[184:199], v[212:215], v[52:55], v[184:199]
    v_cvt_pk_bf16_f32 v200, v168, v169
    v_cvt_pk_bf16_f32 v201, v170, v171
    v_cvt_pk_bf16_f32 v202, v172, v173
    v_cvt_pk_bf16_f32 v203, v174, v175
    v_cvt_pk_bf16_f32 v204, v176, v177
    v_cvt_pk_bf16_f32 v205, v178, v179
    s_waitcnt lgkmcnt(2)
    v_mfma_f32_32x32x16_bf16 v[184:199], v[216:219], v[56:59], v[184:199]
    s_waitcnt lgkmcnt(0)
    s_barrier
    ds_read_b64_tr_b16 v[232:233], v14 offset:0
    ds_read_b64_tr_b16 v[234:235], v14 offset:3072
    ds_read_b64_tr_b16 v[236:237], v14 offset:6144
    ds_read_b64_tr_b16 v[238:239], v14 offset:9216
    v_cvt_pk_bf16_f32 v206, v180, v181
    v_cvt_pk_bf16_f32 v207, v182, v183
    v_mfma_f32_32x32x16_bf16 v[184:199], v[220:223], v[60:63], v[184:199]
    ds_read_b64_tr_b16 v[240:241], v15 offset:64
    ds_read_b64_tr_b16 v[242:243], v15 offset:3136
    ds_read_b64_tr_b16 v[244:245], v15 offset:6208
    ds_read_b64_tr_b16 v[246:247], v15 offset:9280
    v_mfma_f32_32x32x16_bf16 v[184:199], v[224:227], v[64:67], v[184:199]
    ds_read_b64_tr_b16 v[248:249], v14 offset:128
    ds_read_b64_tr_b16 v[250:251], v14 offset:3200
    ds_read_b64_tr_b16 v[252:253], v14 offset:6272
    ds_read_b64_tr_b16 v[254:255], v14 offset:9344
    v_mfma_f32_32x32x16_bf16 v[184:199], v[228:231], v[68:71], v[184:199]
    s_waitcnt lgkmcnt(8)
    v_mfma_f32_32x32x16_bf16 v[72:87], v[232:235], v[200:203], v[72:87]
    v_add_f32 v168, v168, v169
    v_add_f32 v170, v170, v171
    v_add_f32 v172, v172, v173
    v_add_f32 v174, v174, v175
    v_add_f32 v176, v176, v177
    v_add_f32 v178, v178, v179
    v_mfma_f32_32x32x16_bf16 v[72:87], v[236:239], v[204:207], v[72:87]
    ds_read_b64_tr_b16 v[232:233], v15 offset:192
    ds_read_b64_tr_b16 v[234:235], v15 offset:3264
    ds_read_b64_tr_b16 v[236:237], v15 offset:6336
    ds_read_b64_tr_b16 v[238:239], v15 offset:9408
    v_add_f32 v180, v180, v181
    v_add_f32 v182, v182, v183
    v_add_f32 v168, v168, v170
    v_add_f32 v172, v172, v174
    v_add_f32 v176, v176, v178
    v_add_f32 v180, v180, v182
    s_waitcnt lgkmcnt(8)
    v_mfma_f32_32x32x16_bf16 v[88:103], v[240:243], v[200:203], v[88:103]
    v_add_f32 v168, v168, v172
    v_add_f32 v176, v176, v180
    v_add_f32 v168, v168, v176
    v_add_f32 v17, v17, v168
    v_mfma_f32_32x32x16_bf16 v[88:103], v[244:247], v[204:207], v[88:103]
    ds_read_b64_tr_b16 v[240:241], v14 offset:256
    ds_read_b64_tr_b16 v[242:243], v14 offset:3328
    ds_read_b64_tr_b16 v[244:245], v14 offset:6400
    ds_read_b64_tr_b16 v[246:247], v14 offset:9472
    v_max3_f32 v20, v184, v185, v16
    v_max3_f32 v20, v186, v187, v20
    v_max3_f32 v20, v188, v189, v20
    v_max3_f32 v20, v190, v191, v20
    s_waitcnt lgkmcnt(8)
    v_mfma_f32_32x32x16_bf16 v[104:119], v[248:251], v[200:203], v[104:119]
    v_max3_f32 v20, v192, v193, v20
    v_max3_f32 v20, v194, v195, v20
    v_max3_f32 v20, v196, v197, v20
    v_max3_f32 v20, v198, v199, v20
    v_mov_b32 v21, v20
    s_nop 1
    v_mfma_f32_32x32x16_bf16 v[104:119], v[252:255], v[204:207], v[104:119]
    ds_read_b64_tr_b16 v[248:249], v15 offset:320
    ds_read_b64_tr_b16 v[250:251], v15 offset:3392
    ds_read_b64_tr_b16 v[252:253], v15 offset:6464
    ds_read_b64_tr_b16 v[254:255], v15 offset:9536
    v_permlane32_swap_b32 v20, v21
    v_max_f32 v20, v20, v21
    v_sub_f32 v21, v20, v16
    v_cmp_lt_f32 vcc, s46, v21
    s_waitcnt lgkmcnt(8)
    v_mfma_f32_32x32x16_bf16 v[120:135], v[232:235], v[200:203], v[120:135]
    v_add_u32 v10, s33, v4
    v_add_u32 v11, s33, v5
    v_add_u32 v12, s33, v6
    v_add_u32 v13, s33, v7
    s_add_u32 s33, s33, 12288
    s_cmp_eq_u32 s33, 122880
    s_cselect_b32 s33, 0, s33
    s_cbranch_vccnz A_rare1_e
A_back1_e:
    v_fma_f32 v184, v184, s32, -v18
    v_mfma_f32_32x32x16_bf16 v[120:135], v[236:239], v[204:207], v[120:135]
    v_fma_f32 v185, v185, s32, -v18
    v_fma_f32 v186, v186, s32, -v18
    v_fma_f32 v187, v187, s32, -v18
    v_fma_f32 v188, v188, s32, -v18
    v_fma_f32 v189, v189, s32, -v18
    v_fma_f32 v190, v190, s32, -v18
    v_fma_f32 v191, v191, s32, -v18
    v_fma_f32 v192, v192, s32, -v18
    s_waitcnt lgkmcnt(4)
    v_mfma_f32_32x32x16_bf16 v[136:151], v[240:243], v[200:203], v[136:151]
    s_waitcnt lgkmcnt(0)
    s_barrier
    ds_read_b128 v[208:211], v10 offset:0
    ds_read_b128 v[212:215], v11 offset:0
    v_fma_f32 v193, v193, s32, -v18
    v_fma_f32 v194, v194, s32, -v18
    v_fma_f32 v195, v195, s32, -v18
    v_mfma_f32_32x32x16_bf16 v[136:151], v[244:247], v[204:207], v[136:151]
    ds_read_b128 v[216:219], v12 offset:0
    ds_read_b128 v[220:223], v13 offset:0
    v_fma_f32 v196, v196, s32, -v18
    v_fma_f32 v197, v197, s32, -v18
    v_fma_f32 v198, v198, s32, -v18
    v_fma_f32 v199, v199, s32, -v18
    v_exp_f32 v184, v184
    v_mfma_f32_32x32x16_bf16 v[152:167], v[248:251], v[200:203], v[152:167]
    ds_read_b128 v[224:227], v10 offset:128
    ds_read_b128 v[228:231], v11 offset:128
    v_exp_f32 v185, v185
    v_exp_f32 v186, v186
    v_mfma_f32_32x32x16_bf16 v[152:167], v[252:255], v[204:207], v[152:167]
    s_cmp_lg_u32 s47, 0
    s_cbranch_scc1 A_rare2_o
A_back2_o:
    s_waitcnt lgkmcnt(4)
    v_mfma_f32_32x32x16_bf16 v[168:183], v[208:211], v[24:27], 0
    v_exp_f32 v187, v187
    v_exp_f32 v188, v188
    v_mfma_f32_32x32x16_bf16 v[168:183], v[212:215], v[28:31], v[168:183]
    ds_read_b128 v[208:211], v12 offset:128
    ds_read_b128 v[212:215], v13 offset:128
    v_exp_f32 v189, v189
    v_exp_f32 v190, v190
    s_waitcnt lgkmcnt(4)
    v_mfma_f32_32x32x16_bf16 v[168:183], v[216:219], v[32:35], v[168:183]
    v_exp_f32 v191, v191
    v_exp_f32 v192, v192
    v_mfma_f32_32x32x16_bf16 v[168:183], v[220:223], v[36:39], v[168:183]
    ds_read_b128 v[216:219], v10 offset:256
    ds_read_b128 v[220:223], v11 offset:256
    v_exp_f32 v193, v193
    v_exp_f32 v194, v194
    s_waitcnt lgkmcnt(4)
    v_mfma_f32_32x32x16_bf16 v[168:183], v[224:227], v[40:43], v[168:183]
    v_exp_f32 v195, v195
    v_exp_f32 v196, v196
    v_mfma_f32_32x32x16_bf16 v[168:183], v[228:231], v[44:47], v[168:183]
    ds_read_b128 v[224:227], v12 offset:256
    ds_read_b128 v[228:231], v13 offset:256
    v_exp_f32 v197, v197
    v_exp_f32 v198, v198
    s_waitcnt lgkmcnt(4)
    v_mfma_f32_32x32x16_bf16 v[168:183], v[208:211], v[48:51], v[168:183]
    v_add_u32 v14, s33, v8
    v_add_u32 v15, s33, v9
    s_add_u32 s33, s33, 12288
    s_cmp_eq_u32 s33, 122880
    s_cselect_b32 s33, 0, s33
    v_exp_f32 v199, v199
    v_mfma_f32_32x32x16_bf16 v[168:183], v[212:215], v[52:55], v[168:183]
    v_cvt_pk_bf16_f32 v200, v184, v185
    v_cvt_pk_bf16_f32 v201, v186, v187
    v_cvt_pk_bf16_f32 v202, v188, v189
    v_cvt_pk_bf16_f32 v203, v190, v191
    v_cvt_pk_bf16_f32 v204, v192, v193
    v_cvt_pk_bf16_f32 v205, v194, v195
    s_waitcnt lgkmcnt(2)
    v_mfma_f32_32x32x16_bf16 v[168:183], v[216:219], v[56:59], v[168:183]
    s_waitcnt lgkmcnt(0)
    s_barrier
    ds_read_b64_tr_b16 v[232:233], v14 offset:0
    ds_read_b64_tr_b16 v[234:235], v14 offset:3072
    ds_read_b64_tr_b16 v[236:237], v14 offset:6144
    ds_read_b64_tr_b16 v[238:239], v14 offset:9216
    v_cvt_pk_bf16_f32 v206, v196, v197
    v_cvt_pk_bf16_f32 v207, v198, v199
    v_mfma_f32_32x32x16_bf16 v[168:183], v[220:223], v[60:63], v[168:183]
    ds_read_b64_tr_b16 v[240:241], v15 offset:64
    ds_read_b64_tr_b16 v[242:243], v15 offset:3136
    ds_read_b64_tr_b16 v[244:245], v15 offset:6208
    ds_read_b64_tr_b16 v[246:247], v15 offset:9280
    v_mfma_f32_32x32x16_bf16 v[168:183], v[224:227], v[64:67], v[168:183]
    ds_read_b64_tr_b16 v[248:249], v14 offset:128
    ds_read_b64_tr_b16 v[250:251], v14 offset:3200
    ds_read_b64_tr_b16 v[252:253], v14 offset:6272
    ds_read_b64_tr_b16 v[254:255], v14 offset:9344
    v_mfma_f32_32x32x16_bf16 v[168:183], v[228:231], v[68:71], v[168:183]
    s_waitcnt lgkmcnt(8)
    v_mfma_f32_32x32x16_bf16 v[72:87], v[232:235], v[200:203], v[72:87]
    v_add_f32 v184, v184, v185
    v_add_f32 v186, v186, v187
    v_add_f32 v188, v188, v189
    v_add_f32 v190, v190, v191
    v_add_f32 v192, v192, v193
    v_add_f32 v194, v194, v195
    v_mfma_f32_32x32x16_bf16 v[72:87], v[236:239], v[204:207], v[72:87]
    ds_read_b64_tr_b16 v[232:233], v15 offset:192
    ds_read_b64_tr_b16 v[234:235], v15 offset:3264
    ds_read_b64_tr_b16 v[236:237], v15 offset:6336
    ds_read_b64_tr_b16 v[238:239], v15 offset:9408
    v_add_f32 v196, v196, v197
    v_add_f32 v198, v198, v199
    v_add_f32 v184, v184, v186
    v_add_f32 v188, v188, v190
    v_add_f32 v192, v192, v194
    v_add_f32 v196, v196, v198
    s_waitcnt lgkmcnt(8)
    v_mfma_f32_32x32x16_bf16 v[88:103], v[240:243], v[200:203], v[88:103]
    v_add_f32 v184, v184, v188
    v_add_f32 v192, v192, v196
    v_add_f32 v184, v184, v192
    v_add_f32 v17, v17, v184
    v_mfma_f32_32x32x16_bf16 v[88:103], v[244:247], v[204:207], v[88:103]
    ds_read_b64_tr_b16 v[240:241], v14 offset:256
    ds_read_b64_tr_b16 v[242:243], v14 offset:3328
    ds_read_b64_tr_b16 v[244:245], v14 offset:6400
    ds_read_b64_tr_b16 v[246:247], v14 offset:9472
    v_max3_f32 v20, v168, v169, v16
    v_max3_f32 v20, v170, v171, v20
    v_max3_f32 v20, v172, v173, v20
    v_max3_f32 v20, v174, v175, v20
    s_waitcnt lgkmcnt(8)
    v_mfma_f32_32x32x16_bf16 v[104:119], v[248:251], v[200:203], v[104:119]
    v_max3_f32 v20, v176, v177, v20
    v_max3_f32 v20, v178, v179, v20
    v_max3_f32 v20, v180, v181, v20
    v_max3_f32 v20, v182, v183, v20
    v_mov_b32 v21, v20
    s_nop 1
    v_mfma_f32_32x32x16_bf16 v[104:119], v[252:255], v[204:207], v[104:119]
    ds_read_b64_tr_b16 v[248:249], v15 offset:320
    ds_read_b64_tr_b16 v[250:251], v15 offset:3392
    ds_read_b64_tr_b16 v[252:253], v15 offset:6464
    ds_read_b64_tr_b16 v[254:255], v15 offset:9536
    v_permlane32_swap_b32 v20, v21
    v_max_f32 v20, v20, v21
    v_sub_f32 v21, v20, v16
    v_cmp_lt_f32 vcc, s46, v21
    s_waitcnt lgkmcnt(8)
    v_mfma_f32_32x32x16_bf16 v[120:135], v[232:235], v[200:203], v[120:135]
    v_add_u32 v10, s33, v4
    v_add_u32 v11, s33, v5
    v_add_u32 v12, s33, v6
    v_add_u32 v13, s33, v7
    s_add_u32 s33, s33, 12288
    s_cmp_eq_u32 s33, 122880
    s_cselect_b32 s33, 0, s33
    s_cbranch_vccnz A_rare1_o
A_back1_o:
    v_fma_f32 v168, v168, s32, -v18
    v_mfma_f32_32x32x16_bf16 v[120:135], v[236:239], v[204:207], v[120:135]
    v_fma_f32 v169, v169, s32, -v18
    v_fma_f32 v170, v170, s32, -v18
    v_fma_f32 v171, v171, s32, -v18
    v_fma_f32 v172, v172, s32, -v18
    v_fma_f32 v173, v173, s32, -v18
    v_fma_f32 v174, v174, s32, -v18
    v_fma_f32 v175, v175, s32, -v18
    v_fma_f32 v176, v176, s32, -v18
    s_waitcnt lgkmcnt(4)
    v_mfma_f32_32x32x16_bf16 v[136:151], v[240:243], v[200:203], v[136:151]
    s_waitcnt lgkmcnt(0)
    s_barrier
    ds_read_b128 v[208:211], v10 offset:0
    ds_read_b128 v[212:215], v11 offset:0
    v_fma_f32 v177, v177, s32, -v18
    v_fma_f32 v178, v178, s32, -v18
    v_fma_f32 v179, v179, s32, -v18
    v_mfma_f32_32x32x16_bf16 v[136:151], v[244:247], v[204:207], v[136:151]
    ds_read_b128 v[216:219], v12 offset:0
    ds_read_b128 v[220:223], v13 offset:0
    v_fma_f32 v180, v180, s32, -v18
    v_fma_f32 v181, v181, s32, -v18
    v_fma_f32 v182, v182, s32, -v18
    v_fma_f32 v183, v183, s32, -v18
    v_exp_f32 v168, v168
    v_mfma_f32_32x32x16_bf16 v[152:167], v[248:251], v[200:203], v[152:167]
    ds_read_b128 v[224:227], v10 offset:128
    ds_read_b128 v[228:231], v11 offset:128
    v_exp_f32 v169, v169
    v_exp_f32 v170, v170
    v_mfma_f32_32x32x16_bf16 v[152:167], v[252:255], v[204:207], v[152:167]
    s_add_u32 s34, s34, 1
    s_cmp_lt_u32 s34, 15
    s_cbranch_scc1 A_loop
    s_cmp_lg_u32 s47, 0
    s_cbranch_scc1 A_rare2_e2
A_back2_e2:
    s_waitcnt lgkmcnt(4)
    v_mfma_f32_32x32x16_bf16 v[184:199], v[208:211], v[24:27], 0
    v_exp_f32 v171, v171
    v_exp_f32 v172, v172
    v_mfma_f32_32x32x16_bf16 v[184:199], v[212:215], v[28:31], v[184:199]
    ds_read_b128 v[208:211], v12 offset:128
    ds_read_b128 v[212:215], v13 offset:128
    v_exp_f32 v173, v173
    v_exp_f32 v174, v174
    s_waitcnt lgkmcnt(4)
    v_mfma_f32_32x32x16_bf16 v[184:199], v[216:219], v[32:35], v[184:199]
    v_exp_f32 v175, v175
    v_exp_f32 v176, v176
    v_mfma_f32_32x32x16_bf16 v[184:199], v[220:223], v[36:39], v[184:199]
    ds_read_b128 v[216:219], v10 offset:256
    ds_read_b128 v[220:223], v11 offset:256
    v_exp_f32 v177, v177
    v_exp_f32 v178, v178
    s_waitcnt lgkmcnt(4)
    v_mfma_f32_32x32x16_bf16 v[184:199], v[224:227], v[40:43], v[184:199]
    v_exp_f32 v179, v179
    v_exp_f32 v180, v180
    v_mfma_f32_32x32x16_bf16 v[184:199], v[228:231], v[44:47], v[184:199]
    ds_read_b128 v[224:227], v12 offset:256
    ds_read_b128 v[228:231], v13 offset:256
    v_exp_f32 v181, v181
    v_exp_f32 v182, v182
    s_waitcnt lgkmcnt(4)
    v_mfma_f32_32x32x16_bf16 v[184:199], v[208:211], v[48:51], v[184:199]
    v_add_u32 v14, s33, v8
    v_add_u32 v15, s33, v9
    s_add_u32 s33, s33, 12288
    s_cmp_eq_u32 s33, 122880
    s_cselect_b32 s33, 0, s33
    v_exp_f32 v183, v183
    v_mfma_f32_32x32x16_bf16 v[184:199], v[212:215], v[52:55], v[184:199]
    v_cvt_pk_bf16_f32 v200, v168, v169
    v_cvt_pk_bf16_f32 v201, v170, v171
    v_cvt_pk_bf16_f32 v202, v172, v173
    v_cvt_pk_bf16_f32 v203, v174, v175
    v_cvt_pk_bf16_f32 v204, v176, v177
    v_cvt_pk_bf16_f32 v205, v178, v179
    s_waitcnt lgkmcnt(2)
    v_mfma_f32_32x32x16_bf16 v[184:199], v[216:219], v[56:59], v[184:199]
    s_waitcnt lgkmcnt(0)
    s_barrier
    ds_read_b64_tr_b16 v[232:233], v14 offset:0
    ds_read_b64_tr_b16 v[234:235], v14 offset:3072
    ds_read_b64_tr_b16 v[236:237], v14 offset:6144
    ds_read_b64_tr_b16 v[238:239], v14 offset:9216
    v_cvt_pk_bf16_f32 v206, v180, v181
    v_cvt_pk_bf16_f32 v207, v182, v183
    v_mfma_f32_32x32x16_bf16 v[184:199], v[220:223], v[60:63], v[184:199]
    ds_read_b64_tr_b16 v[240:241], v15 offset:64
    ds_read_b64_tr_b16 v[242:243], v15 offset:3136
    ds_read_b64_tr_b16 v[244:245], v15 offset:6208
    ds_read_b64_tr_b16 v[246:247], v15 offset:9280
    v_mfma_f32_32x32x16_bf16 v[184:199], v[224:227], v[64:67], v[184:199]
    ds_read_b64_tr_b16 v[248:249], v14 offset:128
    ds_read_b64_tr_b16 v[250:251], v14 offset:3200
    ds_read_b64_tr_b16 v[252:253], v14 offset:6272
    ds_read_b64_tr_b16 v[254:255], v14 offset:9344
    v_mfma_f32_32x32x16_bf16 v[184:199], v[228:231], v[68:71], v[184:199]
    s_waitcnt lgkmcnt(8)
    v_mfma_f32_32x32x16_bf16 v[72:87], v[232:235], v[200:203], v[72:87]
    v_add_f32 v168, v168, v169
    v_add_f32 v170, v170, v171
    v_add_f32 v172, v172, v173
    v_add_f32 v174, v174, v175
    v_add_f32 v176, v176, v177
    v_add_f32 v178, v178, v179
    v_mfma_f32_32x32x16_bf16 v[72:87], v[236:239], v[204:207], v[72:87]
    ds_read_b64_tr_b16 v[232:233], v15 offset:192
    ds_read_b64_tr_b16 v[234:235], v15 offset:3264
    ds_read_b64_tr_b16 v[236:237], v15 offset:6336
    ds_read_b64_tr_b16 v[238:239], v15 offset:9408
    v_add_f32 v180, v180, v181
    v_add_f32 v182, v182, v183
    v_add_f32 v168, v168, v170
    v_add_f32 v172, v172, v174
    v_add_f32 v176, v176, v178
    v_add_f32 v180, v180, v182
    s_waitcnt lgkmcnt(8)
    v_mfma_f32_32x32x16_bf16 v[88:103], v[240:243], v[200:203], v[88:103]
    v_add_f32 v168, v168, v172
    v_add_f32 v176, v176, v180
    v_add_f32 v168, v168, v176
    v_add_f32 v17, v17, v168
    v_mfma_f32_32x32x16_bf16 v[88:103], v[244:247], v[204:207], v[88:103]
    ds_read_b64_tr_b16 v[240:241], v14 offset:256
    ds_read_b64_tr_b16 v[242:243], v14 offset:3328
    ds_read_b64_tr_b16 v[244:245], v14 offset:6400
    ds_read_b64_tr_b16 v[246:247], v14 offset:9472
    v_max3_f32 v20, v184, v185, v16
    v_max3_f32 v20, v186, v187, v20
    v_max3_f32 v20, v188, v189, v20
    v_max3_f32 v20, v190, v191, v20
    s_waitcnt lgkmcnt(8)
    v_mfma_f32_32x32x16_bf16 v[104:119], v[248:251], v[200:203], v[104:119]
    v_max3_f32 v20, v192, v193, v20
    v_max3_f32 v20, v194, v195, v20
    v_max3_f32 v20, v196, v197, v20
    v_max3_f32 v20, v198, v199, v20
    v_mov_b32 v21, v20
    s_nop 1
    v_mfma_f32_32x32x16_bf16 v[104:119], v[252:255], v[204:207], v[104:119]
    ds_read_b64_tr_b16 v[248:249], v15 offset:320
    ds_read_b64_tr_b16 v[250:251], v15 offset:3392
    ds_read_b64_tr_b16 v[252:253], v15 offset:6464
    ds_read_b64_tr_b16 v[254:255], v15 offset:9536
    v_permlane32_swap_b32 v20, v21
    v_max_f32 v20, v20, v21
    v_sub_f32 v21, v20, v16
    v_cmp_lt_f32 vcc, s46, v21
    s_waitcnt lgkmcnt(8)
    v_mfma_f32_32x32x16_bf16 v[120:135], v[232:235], v[200:203], v[120:135]
    s_cbranch_vccnz A_rare1_e2
A_back1_e2:
    v_fma_f32 v184, v184, s32, -v18
    v_fma_f32 v185, v185, s32, -v18
    v_fma_f32 v186, v186, s32, -v18
    v_fma_f32 v187, v187, s32, -v18
    v_fma_f32 v188, v188, s32, -v18
    v_fma_f32 v189, v189, s32, -v18
    v_mfma_f32_32x32x16_bf16 v[120:135], v[236:239], v[204:207], v[120:135]
    v_fma_f32 v190, v190, s32, -v18
    v_fma_f32 v191, v191, s32, -v18
    v_fma_f32 v192, v192, s32, -v18
    v_fma_f32 v193, v193, s32, -v18
    v_fma_f32 v194, v194, s32, -v18
    v_fma_f32 v195, v195, s32, -v18
    v_fma_f32 v196, v196, s32, -v18
    v_fma_f32 v197, v197, s32, -v18
    s_waitcnt lgkmcnt(4)
    v_mfma_f32_32x32x16_bf16 v[136:151], v[240:243], v[200:203], v[136:151]
    v_fma_f32 v198, v198, s32, -v18
    v_fma_f32 v199, v199, s32, -v18
    v_exp_f32 v184, v184
    v_exp_f32 v185, v185
    v_mfma_f32_32x32x16_bf16 v[136:151], v[244:247], v[204:207], v[136:151]
    v_exp_f32 v186, v186
    s_waitcnt lgkmcnt(0)
    v_mfma_f32_32x32x16_bf16 v[152:167], v[248:251], v[200:203], v[152:167]
    v_mfma_f32_32x32x16_bf16 v[152:167], v[252:255], v[204:207], v[152:167]
    s_cmp_lg_u32 s47, 0
    s_cbranch_scc1 A_rare2_o2
A_back2_o2:
    v_exp_f32 v187, v187
    v_exp_f32 v188, v188
    v_exp_f32 v189, v189
    v_exp_f32 v190, v190
    v_exp_f32 v191, v191
    v_exp_f32 v192, v192
    v_exp_f32 v193, v193
    v_exp_f32 v194, v194
    v_exp_f32 v195, v195
    v_exp_f32 v196, v196
    v_exp_f32 v197, v197
    v_exp_f32 v198, v198
    v_exp_f32 v199, v199
    v_cvt_pk_bf16_f32 v200, v184, v185
    v_cvt_pk_bf16_f32 v201, v186, v187
    v_cvt_pk_bf16_f32 v202, v188, v189
    v_cvt_pk_bf16_f32 v203, v190, v191
    v_cvt_pk_bf16_f32 v204, v192, v193
    v_cvt_pk_bf16_f32 v205, v194, v195
    v_cvt_pk_bf16_f32 v206, v196, v197
    v_cvt_pk_bf16_f32 v207, v198, v199
    v_add_u32 v14, s33, v8
    v_add_u32 v15, s33, v9
    s_add_u32 s33, s33, 12288
    s_cmp_eq_u32 s33, 122880
    s_cselect_b32 s33, 0, s33
    s_waitcnt lgkmcnt(0)
    s_barrier
    ds_read_b64_tr_b16 v[232:233], v14 offset:0
    ds_read_b64_tr_b16 v[234:235], v14 offset:3072
    ds_read_b64_tr_b16 v[236:237], v14 offset:6144
    ds_read_b64_tr_b16 v[238:239], v14 offset:9216
    ds_read_b64_tr_b16 v[240:241], v15 offset:64
    ds_read_b64_tr_b16 v[242:243], v15 offset:3136
    ds_read_b64_tr_b16 v[244:245], v15 offset:6208
    ds_read_b64_tr_b16 v[246:247], v15 offset:9280
    ds_read_b64_tr_b16 v[248:249], v14 offset:128
    ds_read_b64_tr_b16 v[250:251], v14 offset:3200
    ds_read_b64_tr_b16 v[252:253], v14 offset:6272
    ds_read_b64_tr_b16 v[254:255], v14 offset:9344
    s_waitcnt lgkmcnt(8)
    v_mfma_f32_32x32x16_bf16 v[72:87], v[232:235], v[200:203], v[72:87]
    v_add_f32 v184, v184, v185
    v_add_f32 v186, v186, v187
    v_add_f32 v188, v188, v189
    v_add_f32 v190, v190, v191
    v_add_f32 v192, v192, v193
    v_add_f32 v194, v194, v195
    v_mfma_f32_32x32x16_bf16 v[72:87], v[236:239], v[204:207], v[72:87]
    ds_read_b64_tr_b16 v[232:233], v15 offset:192
    ds_read_b64_tr_b16 v[234:235], v15 offset:3264
    ds_read_b64_tr_b16 v[236:237], v15 offset:6336
    ds_read_b64_tr_b16 v[238:239], v15 offset:9408
    v_add_f32 v196, v196, v197
    v_add_f32 v198, v198, v199
    v_add_f32 v184, v184, v186
    v_add_f32 v188, v188, v190
    v_add_f32 v192, v192, v194
    v_add_f32 v196, v196, v198
    s_waitcnt lgkmcnt(8)
    v_mfma_f32_32x32x16_bf16 v[88:103], v[240:243], v[200:203], v[88:103]
    v_add_f32 v184, v184, v188
    v_add_f32 v192, v192, v196
    v_add_f32 v184, v184, v192
    v_add_f32 v17, v17, v184
    v_mfma_f32_32x32x16_bf16 v[88:103], v[244:247], v[204:207], v[88:103]
    ds_read_b64_tr_b16 v[240:241], v14 offset:256
    ds_read_b64_tr_b16 v[242:243], v14 offset:3328
    ds_read_b64_tr_b16 v[244:245], v14 offset:6400
    ds_read_b64_tr_b16 v[246:247], v14 offset:9472
    s_waitcnt lgkmcnt(8)
    v_mfma_f32_32x32x16_bf16 v[104:119], v[248:251], v[200:203], v[104:119]
    v_mfma_f32_32x32x16_bf16 v[104:119], v[252:255], v[204:207], v[104:119]
    ds_read_b64_tr_b16 v[248:249], v15 offset:320
    ds_read_b64_tr_b16 v[250:251], v15 offset:3392
    ds_read_b64_tr_b16 v[252:253], v15 offset:6464
    ds_read_b64_tr_b16 v[254:255], v15 offset:9536
    s_waitcnt lgkmcnt(8)
    v_mfma_f32_32x32x16_bf16 v[120:135], v[232:235], v[200:203], v[120:135]
    v_mfma_f32_32x32x16_bf16 v[120:135], v[236:239], v[204:207], v[120:135]
    s_waitcnt lgkmcnt(4)
    v_mfma_f32_32x32x16_bf16 v[136:151], v[240:243], v[200:203], v[136:151]
    v_mfma_f32_32x32x16_bf16 v[136:151], v[244:247], v[204:207], v[136:151]
    s_waitcnt lgkmcnt(0)
    v_mfma_f32_32x32x16_bf16 v[152:167], v[248:251], v[200:203], v[152:167]
    v_mfma_f32_32x32x16_bf16 v[152:167], v[252:255], v[204:207], v[152:167]
    ds_read_b128 v[24:27], v1 offset:0
    ds_read_b128 v[28:31], v1 offset:1024
    ds_read_b128 v[32:35], v1 offset:2048
    ds_read_b128 v[36:39], v1 offset:3072
    ds_read_b128 v[40:43], v1 offset:4096
    ds_read_b128 v[44:47], v1 offset:5120
    ds_read_b128 v[48:51], v1 offset:6144
    ds_read_b128 v[52:55], v1 offset:7168
    ds_read_b128 v[56:59], v1 offset:8192
    ds_read_b128 v[60:63], v1 offset:9216
    ds_read_b128 v[64:67], v1 offset:10240
    ds_read_b128 v[68:71], v1 offset:11264
    v_mov_b32 v21, v17
    s_nop 1
    v_permlane32_swap_b32 v17, v21
    v_add_f32 v17, v17, v21
    v_rcp_f32 v21, v17
    s_mul_i32 s7, s4, 3
    s_add_u32 s7, s7, s3
    s_mul_i32 s7, s7, 384
    s_mul_i32 s35, s5, 12
    s_add_u32 s7, s7, s35
    s_lshl_b32 s7, s7, 10
    v_lshlrev_b32 v22, 4, v0
    s_nop 7
    v_mul_f32 v72, v72, v21
    v_mul_f32 v73, v73, v21
    v_mul_f32 v74, v74, v21
    v_mul_f32 v75, v75, v21
    v_mul_f32 v76, v76, v21
    v_mul_f32 v77, v77, v21
    v_mul_f32 v78, v78, v21
    v_mul_f32 v79, v79, v21
    v_mul_f32 v80, v80, v21
    v_mul_f32 v81, v81, v21
    v_mul_f32 v82, v82, v21
    v_mul_f32 v83, v83, v21
    v_mul_f32 v84, v84, v21
    v_mul_f32 v85, v85, v21
    v_mul_f32 v86, v86, v21
    v_mul_f32 v87, v87, v21
    v_cvt_pk_bf16_f32 v208, v72, v73
    v_cvt_pk_bf16_f32 v209, v74, v75
    v_cvt_pk_bf16_f32 v210, v76, v77
    v_cvt_pk_bf16_f32 v211, v78, v79
    v_cvt_pk_bf16_f32 v212, v80, v81
    v_cvt_pk_bf16_f32 v213, v82, v83
    v_cvt_pk_bf16_f32 v214, v84, v85
    v_cvt_pk_bf16_f32 v215, v86, v87
    s_nop 1
    v_permlane32_swap_b32 v208, v210
    v_permlane32_swap_b32 v209, v211
    v_permlane32_swap_b32 v212, v214
    v_permlane32_swap_b32 v213, v215
    buffer_store_dwordx4 v[208:211], v22, s[24:27], s7 offen offset:0 sc1
    buffer_store_dwordx4 v[212:215], v22, s[24:27], s7 offen offset:1024 sc1
    s_add_u32 s7, s7, 2048
    v_mul_f32 v88, v88, v21
    v_mul_f32 v89, v89, v21
    v_mul_f32 v90, v90, v21
    v_mul_f32 v91, v91, v21
    v_mul_f32 v92, v92, v21
    v_mul_f32 v93, v93, v21
    v_mul_f32 v94, v94, v21
    v_mul_f32 v95, v95, v21
    v_mul_f32 v96, v96, v21
    v_mul_f32 v97, v97, v21
    v_mul_f32 v98, v98, v21
    v_mul_f32 v99, v99, v21
    v_mul_f32 v100, v100, v21
    v_mul_f32 v101, v101, v21
    v_mul_f32 v102, v102, v21
    v_mul_f32 v103, v103, v21
    v_cvt_pk_bf16_f32 v216, v88, v89
    v_cvt_pk_bf16_f32 v217, v90, v91
    v_cvt_pk_bf16_f32 v218, v92, v93
    v_cvt_pk_bf16_f32 v219, v94, v95
    v_cvt_pk_bf16_f32 v220, v96, v97
    v_cvt_pk_bf16_f32 v221, v98, v99
    v_cvt_pk_bf16_f32 v222, v100, v101
    v_cvt_pk_bf16_f32 v223, v102, v103
    s_nop 1
    v_permlane32_swap_b32 v216, v218
    v_permlane32_swap_b32 v217, v219
    v_permlane32_swap_b32 v220, v222
    v_permlane32_swap_b32 v221, v223
    buffer_store_dwordx4 v[216:219], v22, s[24:27], s7 offen offset:0 sc1
    buffer_store_dwordx4 v[220:223], v22, s[24:27], s7 offen offset:1024 sc1
    s_add_u32 s7, s7, 2048
    v_mul_f32 v104, v104, v21
    v_mul_f32 v105, v105, v21
    v_mul_f32 v106, v106, v21
    v_mul_f32 v107, v107, v21
    v_mul_f32 v108, v108, v21
    v_mul_f32 v109, v109, v21
    v_mul_f32 v110, v110, v21
    v_mul_f32 v111, v111, v21
    v_mul_f32 v112, v112, v21
    v_mul_f32 v113, v113, v21
    v_mul_f32 v114, v114, v21
    v_mul_f32 v115, v115, v21
    v_mul_f32 v116, v116, v21
    v_mul_f32 v117, v117, v21
    v_mul_f32 v118, v118, v21
    v_mul_f32 v119, v119, v21
    v_cvt_pk_bf16_f32 v224, v104, v105
    v_cvt_pk_bf16_f32 v225, v106, v107
    v_cvt_pk_bf16_f32 v226, v108, v109
    v_cvt_pk_bf16_f32 v227, v110, v111
    v_cvt_pk_bf16_f32 v228, v112, v113
    v_cvt_pk_bf16_f32 v229, v114, v115
    v_cvt_pk_bf16_f32 v230, v116, v117
    v_cvt_pk_bf16_f32 v231, v118, v119
    s_nop 1
    v_permlane32_swap_b32 v224, v226
    v_permlane32_swap_b32 v225, v227
    v_permlane32_swap_b32 v228, v230
    v_permlane32_swap_b32 v229, v231
    buffer_store_dwordx4 v[224:227], v22, s[24:27], s7 offen offset:0 sc1
    buffer_store_dwordx4 v[228:231], v22, s[24:27], s7 offen offset:1024 sc1
    s_add_u32 s7, s7, 2048
    v_mul_f32 v120, v120, v21
    v_mul_f32 v121, v121, v21
    v_mul_f32 v122, v122, v21
    v_mul_f32 v123, v123, v21
    v_mul_f32 v124, v124, v21
    v_mul_f32 v125, v125, v21
    v_mul_f32 v126, v126, v21
    v_mul_f32 v127, v127, v21
    v_mul_f32 v128, v128, v21
    v_mul_f32 v129, v129, v21
    v_mul_f32 v130, v130, v21
    v_mul_f32 v131, v131, v21
    v_mul_f32 v132, v132, v21
    v_mul_f32 v133, v133, v21
    v_mul_f32 v134, v134, v21
    v_mul_f32 v135, v135, v21
    v_cvt_pk_bf16_f32 v232, v120, v121
    v_cvt_pk_bf16_f32 v233, v122, v123
    v_cvt_pk_bf16_f32 v234, v124, v125
    v_cvt_pk_bf16_f32 v235, v126, v127
    v_cvt_pk_bf16_f32 v236, v128, v129
    v_cvt_pk_bf16_f32 v237, v130, v131
    v_cvt_pk_bf16_f32 v238, v132, v133
    v_cvt_pk_bf16_f32 v239, v134, v135
    s_nop 1
    v_permlane32_swap_b32 v232, v234
    v_permlane32_swap_b32 v233, v235
    v_permlane32_swap_b32 v236, v238
    v_permlane32_swap_b32 v237, v239
    buffer_store_dwordx4 v[232:235], v22, s[24:27], s7 offen offset:0 sc1
    buffer_store_dwordx4 v[236:239], v22, s[24:27], s7 offen offset:1024 sc1
    s_add_u32 s7, s7, 2048
    v_mul_f32 v136, v136, v21
    v_mul_f32 v137, v137, v21
    v_mul_f32 v138, v138, v21
    v_mul_f32 v139, v139, v21
    v_mul_f32 v140, v140, v21
    v_mul_f32 v141, v141, v21
    v_mul_f32 v142, v142, v21
    v_mul_f32 v143, v143, v21
    v_mul_f32 v144, v144, v21
    v_mul_f32 v145, v145, v21
    v_mul_f32 v146, v146, v21
    v_mul_f32 v147, v147, v21
    v_mul_f32 v148, v148, v21
    v_mul_f32 v149, v149, v21
    v_mul_f32 v150, v150, v21
    v_mul_f32 v151, v151, v21
    v_cvt_pk_bf16_f32 v240, v136, v137
    v_cvt_pk_bf16_f32 v241, v138, v139
    v_cvt_pk_bf16_f32 v242, v140, v141
    v_cvt_pk_bf16_f32 v243, v142, v143
    v_cvt_pk_bf16_f32 v244, v144, v145
    v_cvt_pk_bf16_f32 v245, v146, v147
    v_cvt_pk_bf16_f32 v246, v148, v149
    v_cvt_pk_bf16_f32 v247, v150, v151
    s_nop 1
    v_permlane32_swap_b32 v240, v242
    v_permlane32_swap_b32 v241, v243
    v_permlane32_swap_b32 v244, v246
    v_permlane32_swap_b32 v245, v247
    buffer_store_dwordx4 v[240:243], v22, s[24:27], s7 offen offset:0 sc1
    buffer_store_dwordx4 v[244:247], v22, s[24:27], s7 offen offset:1024 sc1
    s_add_u32 s7, s7, 2048
    v_mul_f32 v152, v152, v21
    v_mul_f32 v153, v153, v21
    v_mul_f32 v154, v154, v21
    v_mul_f32 v155, v155, v21
    v_mul_f32 v156, v156, v21
    v_mul_f32 v157, v157, v21
    v_mul_f32 v158, v158, v21
    v_mul_f32 v159, v159, v21
    v_mul_f32 v160, v160, v21
    v_mul_f32 v161, v161, v21
    v_mul_f32 v162, v162, v21
    v_mul_f32 v163, v163, v21
    v_mul_f32 v164, v164, v21
    v_mul_f32 v165, v165, v21
    v_mul_f32 v166, v166, v21
    v_mul_f32 v167, v167, v21
    v_cvt_pk_bf16_f32 v248, v152, v153
    v_cvt_pk_bf16_f32 v249, v154, v155
    v_cvt_pk_bf16_f32 v250, v156, v157
    v_cvt_pk_bf16_f32 v251, v158, v159
    v_cvt_pk_bf16_f32 v252, v160, v161
    v_cvt_pk_bf16_f32 v253, v162, v163
    v_cvt_pk_bf16_f32 v254, v164, v165
    v_cvt_pk_bf16_f32 v255, v166, v167
    s_nop 1
    v_permlane32_swap_b32 v248, v250
    v_permlane32_swap_b32 v249, v251
    v_permlane32_swap_b32 v252, v254
    v_permlane32_swap_b32 v253, v255
    buffer_store_dwordx4 v[248:251], v22, s[24:27], s7 offen offset:0 sc1
    buffer_store_dwordx4 v[252:255], v22, s[24:27], s7 offen offset:1024 sc1
    s_add_u32 s7, s7, 2048
    s_add_u32 s4, s4, 8
    s_add_u32 s49, s49, 1
    s_cmp_lt_u32 s49, 2
    s_cbranch_scc0 A_fin
    s_waitcnt vmcnt(0)
    s_branch A_item
A_fin:
    s_endpgm
A_rare1_p:
    v_sub_f32 v19, v16, v20
    v_mul_f32 v19, s32, v19
    v_exp_f32 v19, v19
    v_mov_b32 v16, v20
    v_mul_f32 v18, s32, v20
    v_mul_f32 v17, v17, v19
    s_mov_b32 s47, 1
    s_branch A_back1_p
A_rare2_e:
    s_nop 15
    v_mul_f32 v72, v72, v19
    v_mul_f32 v73, v73, v19
    v_mul_f32 v74, v74, v19
    v_mul_f32 v75, v75, v19
    v_mul_f32 v76, v76, v19
    v_mul_f32 v77, v77, v19
    v_mul_f32 v78, v78, v19
    v_mul_f32 v79, v79, v19
    v_mul_f32 v80, v80, v19
    v_mul_f32 v81, v81, v19
    v_mul_f32 v82, v82, v19
    v_mul_f32 v83, v83, v19
    v_mul_f32 v84, v84, v19
    v_mul_f32 v85, v85, v19
    v_mul_f32 v86, v86, v19
    v_mul_f32 v87, v87, v19
    v_mul_f32 v88, v88, v19
    v_mul_f32 v89, v89, v19
    v_mul_f32 v90, v90, v19
    v_mul_f32 v91, v91, v19
    v_mul_f32 v92, v92, v19
    v_mul_f32 v93, v93, v19
    v_mul_f32 v94, v94, v19
    v_mul_f32 v95, v95, v19
    v_mul_f32 v96, v96, v19
    v_mul_f32 v97, v97, v19
    v_mul_f32 v98, v98, v19
    v_mul_f32 v99, v99, v19
    v_mul_f32 v100, v100, v19
    v_mul_f32 v101, v101, v19
    v_mul_f32 v102, v102, v19
    v_mul_f32 v103, v103, v19
    v_mul_f32 v104, v104, v19
    v_mul_f32 v105, v105, v19
    v_mul_f32 v106, v106, v19
    v_mul_f32 v107, v107, v19
    v_mul_f32 v108, v108, v19
    v_mul_f32 v109, v109, v19
    v_mul_f32 v110, v110, v19
    v_mul_f32 v111, v111, v19
    v_mul_f32 v112, v112, v19
    v_mul_f32 v113, v113, v19
    v_mul_f32 v114, v114, v19
    v_mul_f32 v115, v115, v19
    v_mul_f32 v116, v116, v19
    v_mul_f32 v117, v117, v19
    v_mul_f32 v118, v118, v19
    v_mul_f32 v119, v119, v19
    v_mul_f32 v120, v120, v19
    v_mul_f32 v121, v121, v19
    v_mul_f32 v122, v122, v19
    v_mul_f32 v123, v123, v19
    v_mul_f32 v124, v124, v19
    v_mul_f32 v125, v125, v19
    v_mul_f32 v126, v126, v19
    v_mul_f32 v127, v127, v19
    v_mul_f32 v128, v128, v19
    v_mul_f32 v129, v129, v19
    v_mul_f32 v130, v130, v19
    v_mul_f32 v131, v131, v19
    v_mul_f32 v132, v132, v19
    v_mul_f32 v133, v133, v19
    v_mul_f32 v134, v134, v19
    v_mul_f32 v135, v135, v19
    v_mul_f32 v136, v136, v19
    v_mul_f32 v137, v137, v19
    v_mul_f32 v138, v138, v19
    v_mul_f32 v139, v139, v19
    v_mul_f32 v140, v140, v19
    v_mul_f32 v141, v141, v19
    v_mul_f32 v142, v142, v19
    v_mul_f32 v143, v143, v19
    v_mul_f32 v144, v144, v19
    v_mul_f32 v145, v145, v19
    v_mul_f32 v146, v146, v19
    v_mul_f32 v147, v147, v19
    v_mul_f32 v148, v148, v19
    v_mul_f32 v149, v149, v19
    v_mul_f32 v150, v150, v19
    v_mul_f32 v151, v151, v19
    v_mul_f32 v152, v152, v19
    v_mul_f32 v153, v153, v19
    v_mul_f32 v154, v154, v19
    v_mul_f32 v155, v155, v19
    v_mul_f32 v156, v156, v19
    v_mul_f32 v157, v157, v19
    v_mul_f32 v158, v158, v19
    v_mul_f32 v159, v159, v19
    v_mul_f32 v160, v160, v19
    v_mul_f32 v161, v161, v19
    v_mul_f32 v162, v162, v19
    v_mul_f32 v163, v163, v19
    v_mul_f32 v164, v164, v19
    v_mul_f32 v165, v165, v19
    v_mul_f32 v166, v166, v19
    v_mul_f32 v167, v167, v19
    s_mov_b32 s47, 0
    s_branch A_back2_e
A_rare1_e:
    v_sub_f32 v19, v16, v20
    v_mul_f32 v19, s32, v19
    v_exp_f32 v19, v19
    v_mov_b32 v16, v20
    v_mul_f32 v18, s32, v20
    v_mul_f32 v17, v17, v19
    s_mov_b32 s47, 1
    s_branch A_back1_e
A_rare2_o:
    s_nop 15
    v_mul_f32 v72, v72, v19
    v_mul_f32 v73, v73, v19
    v_mul_f32 v74, v74, v19
    v_mul_f32 v75, v75, v19
    v_mul_f32 v76, v76, v19
    v_mul_f32 v77, v77, v19
    v_mul_f32 v78, v78, v19
    v_mul_f32 v79, v79, v19
    v_mul_f32 v80, v80, v19
    v_mul_f32 v81, v81, v19
    v_mul_f32 v82, v82, v19
    v_mul_f32 v83, v83, v19
    v_mul_f32 v84, v84, v19
    v_mul_f32 v85, v85, v19
    v_mul_f32 v86, v86, v19
    v_mul_f32 v87, v87, v19
    v_mul_f32 v88, v88, v19
    v_mul_f32 v89, v89, v19
    v_mul_f32 v90, v90, v19
    v_mul_f32 v91, v91, v19
    v_mul_f32 v92, v92, v19
    v_mul_f32 v93, v93, v19
    v_mul_f32 v94, v94, v19
    v_mul_f32 v95, v95, v19
    v_mul_f32 v96, v96, v19
    v_mul_f32 v97, v97, v19
    v_mul_f32 v98, v98, v19
    v_mul_f32 v99, v99, v19
    v_mul_f32 v100, v100, v19
    v_mul_f32 v101, v101, v19
    v_mul_f32 v102, v102, v19
    v_mul_f32 v103, v103, v19
    v_mul_f32 v104, v104, v19
    v_mul_f32 v105, v105, v19
    v_mul_f32 v106, v106, v19
    v_mul_f32 v107, v107, v19
    v_mul_f32 v108, v108, v19
    v_mul_f32 v109, v109, v19
    v_mul_f32 v110, v110, v19
    v_mul_f32 v111, v111, v19
    v_mul_f32 v112, v112, v19
    v_mul_f32 v113, v113, v19
    v_mul_f32 v114, v114, v19
    v_mul_f32 v115, v115, v19
    v_mul_f32 v116, v116, v19
    v_mul_f32 v117, v117, v19
    v_mul_f32 v118, v118, v19
    v_mul_f32 v119, v119, v19
    v_mul_f32 v120, v120, v19
    v_mul_f32 v121, v121, v19
    v_mul_f32 v122, v122, v19
    v_mul_f32 v123, v123, v19
    v_mul_f32 v124, v124, v19
    v_mul_f32 v125, v125, v19
    v_mul_f32 v126, v126, v19
    v_mul_f32 v127, v127, v19
    v_mul_f32 v128, v128, v19
    v_mul_f32 v129, v129, v19
    v_mul_f32 v130, v130, v19
    v_mul_f32 v131, v131, v19
    v_mul_f32 v132, v132, v19
    v_mul_f32 v133, v133, v19
    v_mul_f32 v134, v134, v19
    v_mul_f32 v135, v135, v19
    v_mul_f32 v136, v136, v19
    v_mul_f32 v137, v137, v19
    v_mul_f32 v138, v138, v19
    v_mul_f32 v139, v139, v19
    v_mul_f32 v140, v140, v19
    v_mul_f32 v141, v141, v19
    v_mul_f32 v142, v142, v19
    v_mul_f32 v143, v143, v19
    v_mul_f32 v144, v144, v19
    v_mul_f32 v145, v145, v19
    v_mul_f32 v146, v146, v19
    v_mul_f32 v147, v147, v19
    v_mul_f32 v148, v148, v19
    v_mul_f32 v149, v149, v19
    v_mul_f32 v150, v150, v19
    v_mul_f32 v151, v151, v19
    v_mul_f32 v152, v152, v19
    v_mul_f32 v153, v153, v19
    v_mul_f32 v154, v154, v19
    v_mul_f32 v155, v155, v19
    v_mul_f32 v156, v156, v19
    v_mul_f32 v157, v157, v19
    v_mul_f32 v158, v158, v19
    v_mul_f32 v159, v159, v19
    v_mul_f32 v160, v160, v19
    v_mul_f32 v161, v161, v19
    v_mul_f32 v162, v162, v19
    v_mul_f32 v163, v163, v19
    v_mul_f32 v164, v164, v19
    v_mul_f32 v165, v165, v19
    v_mul_f32 v166, v166, v19
    v_mul_f32 v167, v167, v19
    s_mov_b32 s47, 0
    s_branch A_back2_o
A_rare1_o:
    v_sub_f32 v19, v16, v20
    v_mul_f32 v19, s32, v19
    v_exp_f32 v19, v19
    v_mov_b32 v16, v20
    v_mul_f32 v18, s32, v20
    v_mul_f32 v17, v17, v19
    s_mov_b32 s47, 1
    s_branch A_back1_o
A_rare2_e2:
    s_nop 15
    v_mul_f32 v72, v72, v19
    v_mul_f32 v73, v73, v19
    v_mul_f32 v74, v74, v19
    v_mul_f32 v75, v75, v19
    v_mul_f32 v76, v76, v19
    v_mul_f32 v77, v77, v19
    v_mul_f32 v78, v78, v19
    v_mul_f32 v79, v79, v19
    v_mul_f32 v80, v80, v19
    v_mul_f32 v81, v81, v19
    v_mul_f32 v82, v82, v19
    v_mul_f32 v83, v83, v19
    v_mul_f32 v84, v84, v19
    v_mul_f32 v85, v85, v19
    v_mul_f32 v86, v86, v19
    v_mul_f32 v87, v87, v19
    v_mul_f32 v88, v88, v19
    v_mul_f32 v89, v89, v19
    v_mul_f32 v90, v90, v19
    v_mul_f32 v91, v91, v19
    v_mul_f32 v92, v92, v19
    v_mul_f32 v93, v93, v19
    v_mul_f32 v94, v94, v19
    v_mul_f32 v95, v95, v19
    v_mul_f32 v96, v96, v19
    v_mul_f32 v97, v97, v19
    v_mul_f32 v98, v98, v19
    v_mul_f32 v99, v99, v19
    v_mul_f32 v100, v100, v19
    v_mul_f32 v101, v101, v19
    v_mul_f32 v102, v102, v19
    v_mul_f32 v103, v103, v19
    v_mul_f32 v104, v104, v19
    v_mul_f32 v105, v105, v19
    v_mul_f32 v106, v106, v19
    v_mul_f32 v107, v107, v19
    v_mul_f32 v108, v108, v19
    v_mul_f32 v109, v109, v19
    v_mul_f32 v110, v110, v19
    v_mul_f32 v111, v111, v19
    v_mul_f32 v112, v112, v19
    v_mul_f32 v113, v113, v19
    v_mul_f32 v114, v114, v19
    v_mul_f32 v115, v115, v19
    v_mul_f32 v116, v116, v19
    v_mul_f32 v117, v117, v19
    v_mul_f32 v118, v118, v19
    v_mul_f32 v119, v119, v19
    v_mul_f32 v120, v120, v19
    v_mul_f32 v121, v121, v19
    v_mul_f32 v122, v122, v19
    v_mul_f32 v123, v123, v19
    v_mul_f32 v124, v124, v19
    v_mul_f32 v125, v125, v19
    v_mul_f32 v126, v126, v19
    v_mul_f32 v127, v127, v19
    v_mul_f32 v128, v128, v19
    v_mul_f32 v129, v129, v19
    v_mul_f32 v130, v130, v19
    v_mul_f32 v131, v131, v19
    v_mul_f32 v132, v132, v19
    v_mul_f32 v133, v133, v19
    v_mul_f32 v134, v134, v19
    v_mul_f32 v135, v135, v19
    v_mul_f32 v136, v136, v19
    v_mul_f32 v137, v137, v19
    v_mul_f32 v138, v138, v19
    v_mul_f32 v139, v139, v19
    v_mul_f32 v140, v140, v19
    v_mul_f32 v141, v141, v19
    v_mul_f32 v142, v142, v19
    v_mul_f32 v143, v143, v19
    v_mul_f32 v144, v144, v19
    v_mul_f32 v145, v145, v19
    v_mul_f32 v146, v146, v19
    v_mul_f32 v147, v147, v19
    v_mul_f32 v148, v148, v19
    v_mul_f32 v149, v149, v19
    v_mul_f32 v150, v150, v19
    v_mul_f32 v151, v151, v19
    v_mul_f32 v152, v152, v19
    v_mul_f32 v153, v153, v19
    v_mul_f32 v154, v154, v19
    v_mul_f32 v155, v155, v19
    v_mul_f32 v156, v156, v19
    v_mul_f32 v157, v157, v19
    v_mul_f32 v158, v158, v19
    v_mul_f32 v159, v159, v19
    v_mul_f32 v160, v160, v19
    v_mul_f32 v161, v161, v19
    v_mul_f32 v162, v162, v19
    v_mul_f32 v163, v163, v19
    v_mul_f32 v164, v164, v19
    v_mul_f32 v165, v165, v19
    v_mul_f32 v166, v166, v19
    v_mul_f32 v167, v167, v19
    s_mov_b32 s47, 0
    s_branch A_back2_e2
A_rare1_e2:
    v_sub_f32 v19, v16, v20
    v_mul_f32 v19, s32, v19
    v_exp_f32 v19, v19
    v_mov_b32 v16, v20
    v_mul_f32 v18, s32, v20
    v_mul_f32 v17, v17, v19
    s_mov_b32 s47, 1
    s_branch A_back1_e2
A_rare2_o2:
    s_nop 15
    v_mul_f32 v72, v72, v19
    v_mul_f32 v73, v73, v19
    v_mul_f32 v74, v74, v19
    v_mul_f32 v75, v75, v19
    v_mul_f32 v76, v76, v19
    v_mul_f32 v77, v77, v19
    v_mul_f32 v78, v78, v19
    v_mul_f32 v79, v79, v19
    v_mul_f32 v80, v80, v19
    v_mul_f32 v81, v81, v19
    v_mul_f32 v82, v82, v19
    v_mul_f32 v83, v83, v19
    v_mul_f32 v84, v84, v19
    v_mul_f32 v85, v85, v19
    v_mul_f32 v86, v86, v19
    v_mul_f32 v87, v87, v19
    v_mul_f32 v88, v88, v19
    v_mul_f32 v89, v89, v19
    v_mul_f32 v90, v90, v19
    v_mul_f32 v91, v91, v19
    v_mul_f32 v92, v92, v19
    v_mul_f32 v93, v93, v19
    v_mul_f32 v94, v94, v19
    v_mul_f32 v95, v95, v19
    v_mul_f32 v96, v96, v19
    v_mul_f32 v97, v97, v19
    v_mul_f32 v98, v98, v19
    v_mul_f32 v99, v99, v19
    v_mul_f32 v100, v100, v19
    v_mul_f32 v101, v101, v19
    v_mul_f32 v102, v102, v19
    v_mul_f32 v103, v103, v19
    v_mul_f32 v104, v104, v19
    v_mul_f32 v105, v105, v19
    v_mul_f32 v106, v106, v19
    v_mul_f32 v107, v107, v19
    v_mul_f32 v108, v108, v19
    v_mul_f32 v109, v109, v19
    v_mul_f32 v110, v110, v19
    v_mul_f32 v111, v111, v19
    v_mul_f32 v112, v112, v19
    v_mul_f32 v113, v113, v19
    v_mul_f32 v114, v114, v19
    v_mul_f32 v115, v115, v19
    v_mul_f32 v116, v116, v19
    v_mul_f32 v117, v117, v19
    v_mul_f32 v118, v118, v19
    v_mul_f32 v119, v119, v19
    v_mul_f32 v120, v120, v19
    v_mul_f32 v121, v121, v19
    v_mul_f32 v122, v122, v19
    v_mul_f32 v123, v123, v19
    v_mul_f32 v124, v124, v19
    v_mul_f32 v125, v125, v19
    v_mul_f32 v126, v126, v19
    v_mul_f32 v127, v127, v19
    v_mul_f32 v128, v128, v19
    v_mul_f32 v129, v129, v19
    v_mul_f32 v130, v130, v19
    v_mul_f32 v131, v131, v19
    v_mul_f32 v132, v132, v19
    v_mul_f32 v133, v133, v19
    v_mul_f32 v134, v134, v19
    v_mul_f32 v135, v135, v19
    v_mul_f32 v136, v136, v19
    v_mul_f32 v137, v137, v19
    v_mul_f32 v138, v138, v19
    v_mul_f32 v139, v139, v19
    v_mul_f32 v140, v140, v19
    v_mul_f32 v141, v141, v19
    v_mul_f32 v142, v142, v19
    v_mul_f32 v143, v143, v19
    v_mul_f32 v144, v144, v19
    v_mul_f32 v145, v145, v19
    v_mul_f32 v146, v146, v19
    v_mul_f32 v147, v147, v19
    v_mul_f32 v148, v148, v19
    v_mul_f32 v149, v149, v19
    v_mul_f32 v150, v150, v19
    v_mul_f32 v151, v151, v19
    v_mul_f32 v152, v152, v19
    v_mul_f32 v153, v153, v19
    v_mul_f32 v154, v154, v19
    v_mul_f32 v155, v155, v19
    v_mul_f32 v156, v156, v19
    v_mul_f32 v157, v157, v19
    v_mul_f32 v158, v158, v19
    v_mul_f32 v159, v159, v19
    v_mul_f32 v160, v160, v19
    v_mul_f32 v161, v161, v19
    v_mul_f32 v162, v162, v19
    v_mul_f32 v163, v163, v19
    v_mul_f32 v164, v164, v19
    v_mul_f32 v165, v165, v19
    v_mul_f32 v166, v166, v19
    v_mul_f32 v167, v167, v19
    s_mov_b32 s47, 0
    s_branch A_back2_o2
A_loadK:
    s_setprio 3
    v_add_u32 v25, 0, v0
    v_mul_u32_u24 v26, 2731, v25
    v_lshrrev_b32 v26, 16, v26
    v_mul_u32_u24 v28, 24, v26
    v_sub_u32 v27, v25, v28
    v_bfe_u32 v28, v26, 1, 3
    v_xor_b32 v29, v27, v28
    v_mul_u32_u24 v26, 384, v26
    v_lshl_add_u32 v32, v29, 4, v26
    v_add_u32 v25, 64, v0
    v_mul_u32_u24 v26, 2731, v25
    v_lshrrev_b32 v26, 16, v26
    v_mul_u32_u24 v28, 24, v26
    v_sub_u32 v27, v25, v28
    v_bfe_u32 v28, v26, 1, 3
    v_xor_b32 v29, v27, v28
    v_mul_u32_u24 v26, 384, v26
    v_lshl_add_u32 v33, v29, 4, v26
    v_add_u32 v25, 128, v0
    v_mul_u32_u24 v26, 2731, v25
    v_lshrrev_b32 v26, 16, v26
    v_mul_u32_u24 v28, 24, v26
    v_sub_u32 v27, v25, v28
    v_bfe_u32 v28, v26, 1, 3
    v_xor_b32 v29, v27, v28
    v_mul_u32_u24 v26, 384, v26
    v_lshl_add_u32 v34, v29, 4, v26
    v_add_u32 v25, 192, v0
    v_mul_u32_u24 v26, 2731, v25
    v_lshrrev_b32 v26, 16, v26
    v_mul_u32_u24 v28, 24, v26
    v_sub_u32 v27, v25, v28
    v_bfe_u32 v28, v26, 1, 3
    v_xor_b32 v29, v27, v28
    v_mul_u32_u24 v26, 384, v26
    v_lshl_add_u32 v35, v29, 4, v26
    v_add_u32 v25, 256, v0
    v_mul_u32_u24 v26, 2731, v25
    v_lshrrev_b32 v26, 16, v26
    v_mul_u32_u24 v28, 24, v26
    v_sub_u32 v27, v25, v28
    v_bfe_u32 v28, v26, 1, 3
    v_xor_b32 v29, v27, v28
    v_mul_u32_u24 v26, 384, v26
    v_lshl_add_u32 v36, v29, 4, v26
    v_add_u32 v25, 320, v0
    v_mul_u32_u24 v26, 2731, v25
    v_lshrrev_b32 v26, 16, v26
    v_mul_u32_u24 v28, 24, v26
    v_sub_u32 v27, v25, v28
    v_bfe_u32 v28, v26, 1, 3
    v_xor_b32 v29, v27, v28
    v_mul_u32_u24 v26, 384, v26
    v_lshl_add_u32 v37, v29, 4, v26
    v_add_u32 v25, 384, v0
    v_mul_u32_u24 v26, 2731, v25
    v_lshrrev_b32 v26, 16, v26
    v_mul_u32_u24 v28, 24, v26
    v_sub_u32 v27, v25, v28
    v_bfe_u32 v28, v26, 1, 3
    v_xor_b32 v29, v27, v28
    v_mul_u32_u24 v26, 384, v26
    v_lshl_add_u32 v38, v29, 4, v26
    v_add_u32 v25, 448, v0
    v_mul_u32_u24 v26, 2731, v25
    v_lshrrev_b32 v26, 16, v26
    v_mul_u32_u24 v28, 24, v26
    v_sub_u32 v27, v25, v28
    v_bfe_u32 v28, v26, 1, 3
    v_xor_b32 v29, v27, v28
    v_mul_u32_u24 v26, 384, v26
    v_lshl_add_u32 v39, v29, 4, v26
    v_add_u32 v25, 512, v0
    v_mul_u32_u24 v26, 2731, v25
    v_lshrrev_b32 v26, 16, v26
    v_mul_u32_u24 v28, 24, v26
    v_sub_u32 v27, v25, v28
    v_bfe_u32 v28, v26, 1, 3
    v_xor_b32 v29, v27, v28
    v_mul_u32_u24 v26, 384, v26
    v_lshl_add_u32 v40, v29, 4, v26
    v_add_u32 v25, 576, v0
    v_mul_u32_u24 v26, 2731, v25
    v_lshrrev_b32 v26, 16, v26
    v_mul_u32_u24 v28, 24, v26
    v_sub_u32 v27, v25, v28
    v_bfe_u32 v28, v26, 1, 3
    v_xor_b32 v29, v27, v28
    v_mul_u32_u24 v26, 384, v26
    v_lshl_add_u32 v41, v29, 4, v26
    v_add_u32 v25, 640, v0
    v_mul_u32_u24 v26, 2731, v25
    v_lshrrev_b32 v26, 16, v26
    v_mul_u32_u24 v28, 24, v26
    v_sub_u32 v27, v25, v28
    v_bfe_u32 v28, v26, 1, 3
    v_xor_b32 v29, v27, v28
    v_mul_u32_u24 v26, 384, v26
    v_lshl_add_u32 v42, v29, 4, v26
    v_add_u32 v25, 704, v0
    v_mul_u32_u24 v26, 2731, v25
    v_lshrrev_b32 v26, 16, v26
    v_mul_u32_u24 v28, 24, v26
    v_sub_u32 v27, v25, v28
    v_bfe_u32 v28, v26, 1, 3
    v_xor_b32 v29, v27, v28
    v_mul_u32_u24 v26, 384, v26
    v_lshl_add_u32 v43, v29, 4, v26
    s_mov_b32 s29, s6
    s_mov_b32 s31, 0
    s_add_u32 m0, s31, 0
    s_nop 0
    buffer_load_dwordx4 v32, s[8:11], s29 offen nt lds
    s_add_u32 m0, s31, 1024
    s_nop 0
    buffer_load_dwordx4 v33, s[8:11], s29 offen nt lds
    s_add_u32 m0, s31, 2048
    s_nop 0
    buffer_load_dwordx4 v34, s[8:11], s29 offen nt lds
    s_add_u32 m0, s31, 3072
    s_nop 0
    buffer_load_dwordx4 v35, s[8:11], s29 offen nt lds
    s_add_u32 m0, s31, 4096
    s_nop 0
    buffer_load_dwordx4 v36, s[8:11], s29 offen nt lds
    s_add_u32 m0, s31, 5120
    s_nop 0
    buffer_load_dwordx4 v37, s[8:11], s29 offen nt lds
    s_add_u32 m0, s31, 6144
    s_nop 0
    buffer_load_dwordx4 v38, s[8:11], s29 offen nt lds
    s_add_u32 m0, s31, 7168
    s_nop 0
    buffer_load_dwordx4 v39, s[8:11], s29 offen nt lds
    s_add_u32 m0, s31, 8192
    s_nop 0
    buffer_load_dwordx4 v40, s[8:11], s29 offen nt lds
    s_add_u32 m0, s31, 9216
    s_nop 0
    buffer_load_dwordx4 v41, s[8:11], s29 offen nt lds
    s_add_u32 m0, s31, 10240
    s_nop 0
    buffer_load_dwordx4 v42, s[8:11], s29 offen nt lds
    s_add_u32 m0, s31, 11264
    s_nop 0
    buffer_load_dwordx4 v43, s[8:11], s29 offen nt lds
    s_add_u32 s29, s29, 12288
    s_add_u32 s31, s31, 12288
    s_cmp_eq_u32 s31, 122880
    s_cselect_b32 s31, 0, s31
    s_add_u32 m0, s31, 0
    s_nop 0
    buffer_load_dwordx4 v32, s[8:11], s29 offen nt lds
    s_add_u32 m0, s31, 1024
    s_nop 0
    buffer_load_dwordx4 v33, s[8:11], s29 offen nt lds
    s_add_u32 m0, s31, 2048
    s_nop 0
    buffer_load_dwordx4 v34, s[8:11], s29 offen nt lds
    s_add_u32 m0, s31, 3072
    s_nop 0
    buffer_load_dwordx4 v35, s[8:11], s29 offen nt lds
    s_add_u32 m0, s31, 4096
    s_nop 0
    buffer_load_dwordx4 v36, s[8:11], s29 offen nt lds
    s_add_u32 m0, s31, 5120
    s_nop 0
    buffer_load_dwordx4 v37, s[8:11], s29 offen nt lds
    s_add_u32 m0, s31, 6144
    s_nop 0
    buffer_load_dwordx4 v38, s[8:11], s29 offen nt lds
    s_add_u32 m0, s31, 7168
    s_nop 0
    buffer_load_dwordx4 v39, s[8:11], s29 offen nt lds
    s_add_u32 m0, s31, 8192
    s_nop 0
    buffer_load_dwordx4 v40, s[8:11], s29 offen nt lds
    s_add_u32 m0, s31, 9216
    s_nop 0
    buffer_load_dwordx4 v41, s[8:11], s29 offen nt lds
    s_add_u32 m0, s31, 10240
    s_nop 0
    buffer_load_dwordx4 v42, s[8:11], s29 offen nt lds
    s_add_u32 m0, s31, 11264
    s_nop 0
    buffer_load_dwordx4 v43, s[8:11], s29 offen nt lds
    s_add_u32 s29, s29, 12288
    s_add_u32 s31, s31, 12288
    s_cmp_eq_u32 s31, 122880
    s_cselect_b32 s31, 0, s31
    s_add_u32 s31, s31, 12288
    s_cmp_eq_u32 s31, 122880
    s_cselect_b32 s31, 0, s31
    s_add_u32 m0, s31, 0
    s_nop 0
    buffer_load_dwordx4 v32, s[8:11], s29 offen nt lds
    s_add_u32 m0, s31, 1024
    s_nop 0
    buffer_load_dwordx4 v33, s[8:11], s29 offen nt lds
    s_add_u32 m0, s31, 2048
    s_nop 0
    buffer_load_dwordx4 v34, s[8:11], s29 offen nt lds
    s_add_u32 m0, s31, 3072
    s_nop 0
    buffer_load_dwordx4 v35, s[8:11], s29 offen nt lds
    s_add_u32 m0, s31, 4096
    s_nop 0
    buffer_load_dwordx4 v36, s[8:11], s29 offen nt lds
    s_add_u32 m0, s31, 5120
    s_nop 0
    buffer_load_dwordx4 v37, s[8:11], s29 offen nt lds
    s_add_u32 m0, s31, 6144
    s_nop 0
    buffer_load_dwordx4 v38, s[8:11], s29 offen nt lds
    s_add_u32 m0, s31, 7168
    s_nop 0
    buffer_load_dwordx4 v39, s[8:11], s29 offen nt lds
    s_add_u32 m0, s31, 8192
    s_nop 0
    buffer_load_dwordx4 v40, s[8:11], s29 offen nt lds
    s_add_u32 m0, s31, 9216
    s_nop 0
    buffer_load_dwordx4 v41, s[8:11], s29 offen nt lds
    s_add_u32 m0, s31, 10240
    s_nop 0
    buffer_load_dwordx4 v42, s[8:11], s29 offen nt lds
    s_add_u32 m0, s31, 11264
    s_nop 0
    buffer_load_dwordx4 v43, s[8:11], s29 offen nt lds
    s_add_u32 s29, s29, 12288
    s_add_u32 s31, s31, 12288
    s_cmp_eq_u32 s31, 122880
    s_cselect_b32 s31, 0, s31
    s_add_u32 s31, s31, 12288
    s_cmp_eq_u32 s31, 122880
    s_cselect_b32 s31, 0, s31
    v_add_u32 v25, 0, v0
    v_mul_u32_u24 v26, 2731, v25
    v_lshrrev_b32 v26, 16, v26
    v_mul_u32_u24 v28, 24, v26
    v_sub_u32 v27, v25, v28
    v_bfe_u32 v28, v26, 1, 1
    v_lshlrev_b32 v28, 2, v28
    v_xor_b32 v27, v27, v28
    v_mul_u32_u24 v26, 12288, v26
    v_lshl_add_u32 v48, v27, 4, v26
    v_add_u32 v25, 64, v0
    v_mul_u32_u24 v26, 2731, v25
    v_lshrrev_b32 v26, 16, v26
    v_mul_u32_u24 v28, 24, v26
    v_sub_u32 v27, v25, v28
    v_bfe_u32 v28, v26, 1, 1
    v_lshlrev_b32 v28, 2, v28
    v_xor_b32 v27, v27, v28
    v_mul_u32_u24 v26, 12288, v26
    v_lshl_add_u32 v49, v27, 4, v26
    v_add_u32 v25, 128, v0
    v_mul_u32_u24 v26, 2731, v25
    v_lshrrev_b32 v26, 16, v26
    v_mul_u32_u24 v28, 24, v26
    v_sub_u32 v27, v25, v28
    v_bfe_u32 v28, v26, 1, 1
    v_lshlrev_b32 v28, 2, v28
    v_xor_b32 v27, v27, v28
    v_mul_u32_u24 v26, 12288, v26
    v_lshl_add_u32 v50, v27, 4, v26
    v_add_u32 v25, 192, v0
    v_mul_u32_u24 v26, 2731, v25
    v_lshrrev_b32 v26, 16, v26
    v_mul_u32_u24 v28, 24, v26
    v_sub_u32 v27, v25, v28
    v_bfe_u32 v28, v26, 1, 1
    v_lshlrev_b32 v28, 2, v28
    v_xor_b32 v27, v27, v28
    v_mul_u32_u24 v26, 12288, v26
    v_lshl_add_u32 v51, v27, 4, v26
    v_add_u32 v25, 256, v0
    v_mul_u32_u24 v26, 2731, v25
    v_lshrrev_b32 v26, 16, v26
    v_mul_u32_u24 v28, 24, v26
    v_sub_u32 v27, v25, v28
    v_bfe_u32 v28, v26, 1, 1
    v_lshlrev_b32 v28, 2, v28
    v_xor_b32 v27, v27, v28
    v_mul_u32_u24 v26, 12288, v26
    v_lshl_add_u32 v52, v27, 4, v26
    v_add_u32 v25, 320, v0
    v_mul_u32_u24 v26, 2731, v25
    v_lshrrev_b32 v26, 16, v26
    v_mul_u32_u24 v28, 24, v26
    v_sub_u32 v27, v25, v28
    v_bfe_u32 v28, v26, 1, 1
    v_lshlrev_b32 v28, 2, v28
    v_xor_b32 v27, v27, v28
    v_mul_u32_u24 v26, 12288, v26
    v_lshl_add_u32 v53, v27, 4, v26
    v_add_u32 v25, 384, v0
    v_mul_u32_u24 v26, 2731, v25
    v_lshrrev_b32 v26, 16, v26
    v_mul_u32_u24 v28, 24, v26
    v_sub_u32 v27, v25, v28
    v_bfe_u32 v28, v26, 1, 1
    v_lshlrev_b32 v28, 2, v28
    v_xor_b32 v27, v27, v28
    v_mul_u32_u24 v26, 12288, v26
    v_lshl_add_u32 v54, v27, 4, v26
    v_add_u32 v25, 448, v0
    v_mul_u32_u24 v26, 2731, v25
    v_lshrrev_b32 v26, 16, v26
    v_mul_u32_u24 v28, 24, v26
    v_sub_u32 v27, v25, v28
    v_bfe_u32 v28, v26, 1, 1
    v_lshlrev_b32 v28, 2, v28
    v_xor_b32 v27, v27, v28
    v_mul_u32_u24 v26, 12288, v26
    v_lshl_add_u32 v55, v27, 4, v26
    v_add_u32 v25, 512, v0
    v_mul_u32_u24 v26, 2731, v25
    v_lshrrev_b32 v26, 16, v26
    v_mul_u32_u24 v28, 24, v26
    v_sub_u32 v27, v25, v28
    v_bfe_u32 v28, v26, 1, 1
    v_lshlrev_b32 v28, 2, v28
    v_xor_b32 v27, v27, v28
    v_mul_u32_u24 v26, 12288, v26
    v_lshl_add_u32 v56, v27, 4, v26
    v_add_u32 v25, 576, v0
    v_mul_u32_u24 v26, 2731, v25
    v_lshrrev_b32 v26, 16, v26
    v_mul_u32_u24 v28, 24, v26
    v_sub_u32 v27, v25, v28
    v_bfe_u32 v28, v26, 1, 1
    v_lshlrev_b32 v28, 2, v28
    v_xor_b32 v27, v27, v28
    v_mul_u32_u24 v26, 12288, v26
    v_lshl_add_u32 v57, v27, 4, v26
    v_add_u32 v25, 640, v0
    v_mul_u32_u24 v26, 2731, v25
    v_lshrrev_b32 v26, 16, v26
    v_mul_u32_u24 v28, 24, v26
    v_sub_u32 v27, v25, v28
    v_bfe_u32 v28, v26, 1, 1
    v_lshlrev_b32 v28, 2, v28
    v_xor_b32 v27, v27, v28
    v_mul_u32_u24 v26, 12288, v26
    v_lshl_add_u32 v58, v27, 4, v26
    v_add_u32 v25, 704, v0
    v_mul_u32_u24 v26, 2731, v25
    v_lshrrev_b32 v26, 16, v26
    v_mul_u32_u24 v28, 24, v26
    v_sub_u32 v27, v25, v28
    v_bfe_u32 v28, v26, 1, 1
    v_lshlrev_b32 v28, 2, v28
    v_xor_b32 v27, v27, v28
    v_mul_u32_u24 v26, 12288, v26
    v_lshl_add_u32 v59, v27, 4, v26
    s_mul_i32 s35, s5, 384
    s_barrier
    s_barrier
    s_waitcnt vmcnt(48)
    s_add_u32 s34, s35, 1572864
    s_mov_b32 m0, 122880
    s_nop 0
    buffer_load_dwordx4 v48, s[16:19], s34 offen lds
    s_mov_b32 m0, 123904
    s_nop 0
    buffer_load_dwordx4 v49, s[16:19], s34 offen lds
    s_mov_b32 m0, 124928
    s_nop 0
    buffer_load_dwordx4 v50, s[16:19], s34 offen lds
    s_mov_b32 m0, 125952
    s_nop 0
    buffer_load_dwordx4 v51, s[16:19], s34 offen lds
    s_mov_b32 m0, 126976
    s_nop 0
    buffer_load_dwordx4 v52, s[16:19], s34 offen lds
    s_mov_b32 m0, 128000
    s_nop 0
    buffer_load_dwordx4 v53, s[16:19], s34 offen lds
    s_mov_b32 m0, 129024
    s_nop 0
    buffer_load_dwordx4 v54, s[16:19], s34 offen lds
    s_mov_b32 m0, 130048
    s_nop 0
    buffer_load_dwordx4 v55, s[16:19], s34 offen lds
    s_mov_b32 m0, 131072
    s_nop 0
    buffer_load_dwordx4 v56, s[16:19], s34 offen lds
    s_mov_b32 m0, 132096
    s_nop 0
    buffer_load_dwordx4 v57, s[16:19], s34 offen lds
    s_mov_b32 m0, 133120
    s_nop 0
    buffer_load_dwordx4 v58, s[16:19], s34 offen lds
    s_mov_b32 m0, 134144
    s_nop 0
    buffer_load_dwordx4 v59, s[16:19], s34 offen lds
    s_barrier
    s_waitcnt vmcnt(48)
    s_add_u32 s34, s35, 1966080
    s_mov_b32 m0, 135168
    s_nop 0
    buffer_load_dwordx4 v48, s[16:19], s34 offen lds
    s_mov_b32 m0, 136192
    s_nop 0
    buffer_load_dwordx4 v49, s[16:19], s34 offen lds
    s_mov_b32 m0, 137216
    s_nop 0
    buffer_load_dwordx4 v50, s[16:19], s34 offen lds
    s_mov_b32 m0, 138240
    s_nop 0
    buffer_load_dwordx4 v51, s[16:19], s34 offen lds
    s_mov_b32 m0, 139264
    s_nop 0
    buffer_load_dwordx4 v52, s[16:19], s34 offen lds
    s_mov_b32 m0, 140288
    s_nop 0
    buffer_load_dwordx4 v53, s[16:19], s34 offen lds
    s_mov_b32 m0, 141312
    s_nop 0
    buffer_load_dwordx4 v54, s[16:19], s34 offen lds
    s_mov_b32 m0, 142336
    s_nop 0
    buffer_load_dwordx4 v55, s[16:19], s34 offen lds
    s_mov_b32 m0, 143360
    s_nop 0
    buffer_load_dwordx4 v56, s[16:19], s34 offen lds
    s_mov_b32 m0, 144384
    s_nop 0
    buffer_load_dwordx4 v57, s[16:19], s34 offen lds
    s_mov_b32 m0, 145408
    s_nop 0
    buffer_load_dwordx4 v58, s[16:19], s34 offen lds
    s_mov_b32 m0, 146432
    s_nop 0
    buffer_load_dwordx4 v59, s[16:19], s34 offen lds
    s_barrier
    s_waitcnt vmcnt(48)
    s_add_u32 s34, s35, 2359296
    s_mov_b32 m0, 147456
    s_nop 0
    buffer_load_dwordx4 v48, s[16:19], s34 offen lds
    s_mov_b32 m0, 148480
    s_nop 0
    buffer_load_dwordx4 v49, s[16:19], s34 offen lds
    s_mov_b32 m0, 149504
    s_nop 0
    buffer_load_dwordx4 v50, s[16:19], s34 offen lds
    s_mov_b32 m0, 150528
    s_nop 0
    buffer_load_dwordx4 v51, s[16:19], s34 offen lds
    s_mov_b32 m0, 151552
    s_nop 0
    buffer_load_dwordx4 v52, s[16:19], s34 offen lds
    s_mov_b32 m0, 152576
    s_nop 0
    buffer_load_dwordx4 v53, s[16:19], s34 offen lds
    s_mov_b32 m0, 153600
    s_nop 0
    buffer_load_dwordx4 v54, s[16:19], s34 offen lds
    s_mov_b32 m0, 154624
    s_nop 0
    buffer_load_dwordx4 v55, s[16:19], s34 offen lds
    s_mov_b32 m0, 155648
    s_nop 0
    buffer_load_dwordx4 v56, s[16:19], s34 offen lds
    s_mov_b32 m0, 156672
    s_nop 0
    buffer_load_dwordx4 v57, s[16:19], s34 offen lds
    s_mov_b32 m0, 157696
    s_nop 0
    buffer_load_dwordx4 v58, s[16:19], s34 offen lds
    s_mov_b32 m0, 158720
    s_nop 0
    buffer_load_dwordx4 v59, s[16:19], s34 offen lds
    s_waitcnt vmcnt(24)
    s_barrier
    s_waitcnt vmcnt(48)
    s_add_u32 s34, s35, 2752512
    s_mov_b32 m0, 110592
    s_nop 0
    buffer_load_dwordx4 v48, s[16:19], s34 offen lds
    s_mov_b32 m0, 111616
    s_nop 0
    buffer_load_dwordx4 v49, s[16:19], s34 offen lds
    s_mov_b32 m0, 112640
    s_nop 0
    buffer_load_dwordx4 v50, s[16:19], s34 offen lds
    s_mov_b32 m0, 113664
    s_nop 0
    buffer_load_dwordx4 v51, s[16:19], s34 offen lds
    s_mov_b32 m0, 114688
    s_nop 0
    buffer_load_dwordx4 v52, s[16:19], s34 offen lds
    s_mov_b32 m0, 115712
    s_nop 0
    buffer_load_dwordx4 v53, s[16:19], s34 offen lds
    s_mov_b32 m0, 116736
    s_nop 0
    buffer_load_dwordx4 v54, s[16:19], s34 offen lds
    s_mov_b32 m0, 117760
    s_nop 0
    buffer_load_dwordx4 v55, s[16:19], s34 offen lds
    s_mov_b32 m0, 118784
    s_nop 0
    buffer_load_dwordx4 v56, s[16:19], s34 offen lds
    s_mov_b32 m0, 119808
    s_nop 0
    buffer_load_dwordx4 v57, s[16:19], s34 offen lds
    s_mov_b32 m0, 120832
    s_nop 0
    buffer_load_dwordx4 v58, s[16:19], s34 offen lds
    s_mov_b32 m0, 121856
    s_nop 0
    buffer_load_dwordx4 v59, s[16:19], s34 offen lds
    s_waitcnt vmcnt(24)
    s_barrier
    s_waitcnt vmcnt(48)
    s_add_u32 s34, s35, 3145728
    s_mov_b32 m0, 122880
    s_nop 0
    buffer_load_dwordx4 v48, s[16:19], s34 offen lds
    s_mov_b32 m0, 123904
    s_nop 0
    buffer_load_dwordx4 v49, s[16:19], s34 offen lds
    s_mov_b32 m0, 124928
    s_nop 0
    buffer_load_dwordx4 v50, s[16:19], s34 offen lds
    s_mov_b32 m0, 125952
    s_nop 0
    buffer_load_dwordx4 v51, s[16:19], s34 offen lds
    s_mov_b32 m0, 126976
    s_nop 0
    buffer_load_dwordx4 v52, s[16:19], s34 offen lds
    s_mov_b32 m0, 128000
    s_nop 0
    buffer_load_dwordx4 v53, s[16:19], s34 offen lds
    s_mov_b32 m0, 129024
    s_nop 0
    buffer_load_dwordx4 v54, s[16:19], s34 offen lds
    s_mov_b32 m0, 130048
    s_nop 0
    buffer_load_dwordx4 v55, s[16:19], s34 offen lds
    s_mov_b32 m0, 131072
    s_nop 0
    buffer_load_dwordx4 v56, s[16:19], s34 offen lds
    s_mov_b32 m0, 132096
    s_nop 0
    buffer_load_dwordx4 v57, s[16:19], s34 offen lds
    s_mov_b32 m0, 133120
    s_nop 0
    buffer_load_dwordx4 v58, s[16:19], s34 offen lds
    s_mov_b32 m0, 134144
    s_nop 0
    buffer_load_dwordx4 v59, s[16:19], s34 offen lds
    s_waitcnt vmcnt(24)
    s_barrier
    s_waitcnt vmcnt(48)
    s_add_u32 s34, s35, 3538944
    s_mov_b32 m0, 135168
    s_nop 0
    buffer_load_dwordx4 v48, s[16:19], s34 offen lds
    s_mov_b32 m0, 136192
    s_nop 0
    buffer_load_dwordx4 v49, s[16:19], s34 offen lds
    s_mov_b32 m0, 137216
    s_nop 0
    buffer_load_dwordx4 v50, s[16:19], s34 offen lds
    s_mov_b32 m0, 138240
    s_nop 0
    buffer_load_dwordx4 v51, s[16:19], s34 offen lds
    s_mov_b32 m0, 139264
    s_nop 0
    buffer_load_dwordx4 v52, s[16:19], s34 offen lds
    s_mov_b32 m0, 140288
    s_nop 0
    buffer_load_dwordx4 v53, s[16:19], s34 offen lds
    s_mov_b32 m0, 141312
    s_nop 0
    buffer_load_dwordx4 v54, s[16:19], s34 offen lds
    s_mov_b32 m0, 142336
    s_nop 0
    buffer_load_dwordx4 v55, s[16:19], s34 offen lds
    s_mov_b32 m0, 143360
    s_nop 0
    buffer_load_dwordx4 v56, s[16:19], s34 offen lds
    s_mov_b32 m0, 144384
    s_nop 0
    buffer_load_dwordx4 v57, s[16:19], s34 offen lds
    s_mov_b32 m0, 145408
    s_nop 0
    buffer_load_dwordx4 v58, s[16:19], s34 offen lds
    s_mov_b32 m0, 146432
    s_nop 0
    buffer_load_dwordx4 v59, s[16:19], s34 offen lds
    s_waitcnt vmcnt(24)
    s_barrier
    s_waitcnt vmcnt(48)
    s_add_u32 s34, s35, 3932160
    s_mov_b32 m0, 147456
    s_nop 0
    buffer_load_dwordx4 v48, s[16:19], s34 offen lds
    s_mov_b32 m0, 148480
    s_nop 0
    buffer_load_dwordx4 v49, s[16:19], s34 offen lds
    s_mov_b32 m0, 149504
    s_nop 0
    buffer_load_dwordx4 v50, s[16:19], s34 offen lds
    s_mov_b32 m0, 150528
    s_nop 0
    buffer_load_dwordx4 v51, s[16:19], s34 offen lds
    s_mov_b32 m0, 151552
    s_nop 0
    buffer_load_dwordx4 v52, s[16:19], s34 offen lds
    s_mov_b32 m0, 152576
    s_nop 0
    buffer_load_dwordx4 v53, s[16:19], s34 offen lds
    s_mov_b32 m0, 153600
    s_nop 0
    buffer_load_dwordx4 v54, s[16:19], s34 offen lds
    s_mov_b32 m0, 154624
    s_nop 0
    buffer_load_dwordx4 v55, s[16:19], s34 offen lds
    s_mov_b32 m0, 155648
    s_nop 0
    buffer_load_dwordx4 v56, s[16:19], s34 offen lds
    s_mov_b32 m0, 156672
    s_nop 0
    buffer_load_dwordx4 v57, s[16:19], s34 offen lds
    s_mov_b32 m0, 157696
    s_nop 0
    buffer_load_dwordx4 v58, s[16:19], s34 offen lds
    s_mov_b32 m0, 158720
    s_nop 0
    buffer_load_dwordx4 v59, s[16:19], s34 offen lds
    s_waitcnt vmcnt(24)
    s_barrier
    s_waitcnt vmcnt(48)
    s_add_u32 s34, s35, 4325376
    s_mov_b32 m0, 110592
    s_nop 0
    buffer_load_dwordx4 v48, s[16:19], s34 offen lds
    s_mov_b32 m0, 111616
    s_nop 0
    buffer_load_dwordx4 v49, s[16:19], s34 offen lds
    s_mov_b32 m0, 112640
    s_nop 0
    buffer_load_dwordx4 v50, s[16:19], s34 offen lds
    s_mov_b32 m0, 113664
    s_nop 0
    buffer_load_dwordx4 v51, s[16:19], s34 offen lds
    s_mov_b32 m0, 114688
    s_nop 0
    buffer_load_dwordx4 v52, s[16:19], s34 offen lds
    s_mov_b32 m0, 115712
    s_nop 0
    buffer_load_dwordx4 v53, s[16:19], s34 offen lds
    s_mov_b32 m0, 116736
    s_nop 0
    buffer_load_dwordx4 v54, s[16:19], s34 offen lds
    s_mov_b32 m0, 117760
    s_nop 0
    buffer_load_dwordx4 v55, s[16:19], s34 offen lds
    s_mov_b32 m0, 118784
    s_nop 0
    buffer_load_dwordx4 v56, s[16:19], s34 offen lds
    s_mov_b32 m0, 119808
    s_nop 0
    buffer_load_dwordx4 v57, s[16:19], s34 offen lds
    s_mov_b32 m0, 120832
    s_nop 0
    buffer_load_dwordx4 v58, s[16:19], s34 offen lds
    s_mov_b32 m0, 121856
    s_nop 0
    buffer_load_dwordx4 v59, s[16:19], s34 offen lds
    s_waitcnt vmcnt(24)
    s_barrier
    s_waitcnt vmcnt(48)
    s_add_u32 s34, s35, 4718592
    s_mov_b32 m0, 122880
    s_nop 0
    buffer_load_dwordx4 v48, s[16:19], s34 offen lds
    s_mov_b32 m0, 123904
    s_nop 0
    buffer_load_dwordx4 v49, s[16:19], s34 offen lds
    s_mov_b32 m0, 124928
    s_nop 0
    buffer_load_dwordx4 v50, s[16:19], s34 offen lds
    s_mov_b32 m0, 125952
    s_nop 0
    buffer_load_dwordx4 v51, s[16:19], s34 offen lds
    s_mov_b32 m0, 126976
    s_nop 0
    buffer_load_dwordx4 v52, s[16:19], s34 offen lds
    s_mov_b32 m0, 128000
    s_nop 0
    buffer_load_dwordx4 v53, s[16:19], s34 offen lds
    s_mov_b32 m0, 129024
    s_nop 0
    buffer_load_dwordx4 v54, s[16:19], s34 offen lds
    s_mov_b32 m0, 130048
    s_nop 0
    buffer_load_dwordx4 v55, s[16:19], s34 offen lds
    s_mov_b32 m0, 131072
    s_nop 0
    buffer_load_dwordx4 v56, s[16:19], s34 offen lds
    s_mov_b32 m0, 132096
    s_nop 0
    buffer_load_dwordx4 v57, s[16:19], s34 offen lds
    s_mov_b32 m0, 133120
    s_nop 0
    buffer_load_dwordx4 v58, s[16:19], s34 offen lds
    s_mov_b32 m0, 134144
    s_nop 0
    buffer_load_dwordx4 v59, s[16:19], s34 offen lds
    s_waitcnt vmcnt(24)
    s_barrier
    s_waitcnt vmcnt(48)
    s_add_u32 s34, s35, 5111808
    s_mov_b32 m0, 135168
    s_nop 0
    buffer_load_dwordx4 v48, s[16:19], s34 offen lds
    s_mov_b32 m0, 136192
    s_nop 0
    buffer_load_dwordx4 v49, s[16:19], s34 offen lds
    s_mov_b32 m0, 137216
    s_nop 0
    buffer_load_dwordx4 v50, s[16:19], s34 offen lds
    s_mov_b32 m0, 138240
    s_nop 0
    buffer_load_dwordx4 v51, s[16:19], s34 offen lds
    s_mov_b32 m0, 139264
    s_nop 0
    buffer_load_dwordx4 v52, s[16:19], s34 offen lds
    s_mov_b32 m0, 140288
    s_nop 0
    buffer_load_dwordx4 v53, s[16:19], s34 offen lds
    s_mov_b32 m0, 141312
    s_nop 0
    buffer_load_dwordx4 v54, s[16:19], s34 offen lds
    s_mov_b32 m0, 142336
    s_nop 0
    buffer_load_dwordx4 v55, s[16:19], s34 offen lds
    s_mov_b32 m0, 143360
    s_nop 0
    buffer_load_dwordx4 v56, s[16:19], s34 offen lds
    s_mov_b32 m0, 144384
    s_nop 0
    buffer_load_dwordx4 v57, s[16:19], s34 offen lds
    s_mov_b32 m0, 145408
    s_nop 0
    buffer_load_dwordx4 v58, s[16:19], s34 offen lds
    s_mov_b32 m0, 146432
    s_nop 0
    buffer_load_dwordx4 v59, s[16:19], s34 offen lds
    s_waitcnt vmcnt(24)
    s_barrier
    s_waitcnt vmcnt(48)
    s_add_u32 s34, s35, 5505024
    s_mov_b32 m0, 147456
    s_nop 0
    buffer_load_dwordx4 v48, s[16:19], s34 offen lds
    s_mov_b32 m0, 148480
    s_nop 0
    buffer_load_dwordx4 v49, s[16:19], s34 offen lds
    s_mov_b32 m0, 149504
    s_nop 0
    buffer_load_dwordx4 v50, s[16:19], s34 offen lds
    s_mov_b32 m0, 150528
    s_nop 0
    buffer_load_dwordx4 v51, s[16:19], s34 offen lds
    s_mov_b32 m0, 151552
    s_nop 0
    buffer_load_dwordx4 v52, s[16:19], s34 offen lds
    s_mov_b32 m0, 152576
    s_nop 0
    buffer_load_dwordx4 v53, s[16:19], s34 offen lds
    s_mov_b32 m0, 153600
    s_nop 0
    buffer_load_dwordx4 v54, s[16:19], s34 offen lds
    s_mov_b32 m0, 154624
    s_nop 0
    buffer_load_dwordx4 v55, s[16:19], s34 offen lds
    s_mov_b32 m0, 155648
    s_nop 0
    buffer_load_dwordx4 v56, s[16:19], s34 offen lds
    s_mov_b32 m0, 156672
    s_nop 0
    buffer_load_dwordx4 v57, s[16:19], s34 offen lds
    s_mov_b32 m0, 157696
    s_nop 0
    buffer_load_dwordx4 v58, s[16:19], s34 offen lds
    s_mov_b32 m0, 158720
    s_nop 0
    buffer_load_dwordx4 v59, s[16:19], s34 offen lds
    s_waitcnt vmcnt(24)
    s_barrier
    s_waitcnt vmcnt(48)
    s_add_u32 s34, s35, 5898240
    s_mov_b32 m0, 110592
    s_nop 0
    buffer_load_dwordx4 v48, s[16:19], s34 offen lds
    s_mov_b32 m0, 111616
    s_nop 0
    buffer_load_dwordx4 v49, s[16:19], s34 offen lds
    s_mov_b32 m0, 112640
    s_nop 0
    buffer_load_dwordx4 v50, s[16:19], s34 offen lds
    s_mov_b32 m0, 113664
    s_nop 0
    buffer_load_dwordx4 v51, s[16:19], s34 offen lds
    s_mov_b32 m0, 114688
    s_nop 0
    buffer_load_dwordx4 v52, s[16:19], s34 offen lds
    s_mov_b32 m0, 115712
    s_nop 0
    buffer_load_dwordx4 v53, s[16:19], s34 offen lds
    s_mov_b32 m0, 116736
    s_nop 0
    buffer_load_dwordx4 v54, s[16:19], s34 offen lds
    s_mov_b32 m0, 117760
    s_nop 0
    buffer_load_dwordx4 v55, s[16:19], s34 offen lds
    s_mov_b32 m0, 118784
    s_nop 0
    buffer_load_dwordx4 v56, s[16:19], s34 offen lds
    s_mov_b32 m0, 119808
    s_nop 0
    buffer_load_dwordx4 v57, s[16:19], s34 offen lds
    s_mov_b32 m0, 120832
    s_nop 0
    buffer_load_dwordx4 v58, s[16:19], s34 offen lds
    s_mov_b32 m0, 121856
    s_nop 0
    buffer_load_dwordx4 v59, s[16:19], s34 offen lds
    s_waitcnt vmcnt(24)
    s_barrier
    s_waitcnt vmcnt(48)
    s_add_u32 s34, s35, 6291456
    s_mov_b32 m0, 122880
    s_nop 0
    buffer_load_dwordx4 v48, s[16:19], s34 offen lds
    s_mov_b32 m0, 123904
    s_nop 0
    buffer_load_dwordx4 v49, s[16:19], s34 offen lds
    s_mov_b32 m0, 124928
    s_nop 0
    buffer_load_dwordx4 v50, s[16:19], s34 offen lds
    s_mov_b32 m0, 125952
    s_nop 0
    buffer_load_dwordx4 v51, s[16:19], s34 offen lds
    s_mov_b32 m0, 126976
    s_nop 0
    buffer_load_dwordx4 v52, s[16:19], s34 offen lds
    s_mov_b32 m0, 128000
    s_nop 0
    buffer_load_dwordx4 v53, s[16:19], s34 offen lds
    s_mov_b32 m0, 129024
    s_nop 0
    buffer_load_dwordx4 v54, s[16:19], s34 offen lds
    s_mov_b32 m0, 130048
    s_nop 0
    buffer_load_dwordx4 v55, s[16:19], s34 offen lds
    s_mov_b32 m0, 131072
    s_nop 0
    buffer_load_dwordx4 v56, s[16:19], s34 offen lds
    s_mov_b32 m0, 132096
    s_nop 0
    buffer_load_dwordx4 v57, s[16:19], s34 offen lds
    s_mov_b32 m0, 133120
    s_nop 0
    buffer_load_dwordx4 v58, s[16:19], s34 offen lds
    s_mov_b32 m0, 134144
    s_nop 0
    buffer_load_dwordx4 v59, s[16:19], s34 offen lds
    s_waitcnt vmcnt(24)
    s_barrier
    s_waitcnt vmcnt(48)
    s_add_u32 s34, s35, 6684672
    s_mov_b32 m0, 135168
    s_nop 0
    buffer_load_dwordx4 v48, s[16:19], s34 offen lds
    s_mov_b32 m0, 136192
    s_nop 0
    buffer_load_dwordx4 v49, s[16:19], s34 offen lds
    s_mov_b32 m0, 137216
    s_nop 0
    buffer_load_dwordx4 v50, s[16:19], s34 offen lds
    s_mov_b32 m0, 138240
    s_nop 0
    buffer_load_dwordx4 v51, s[16:19], s34 offen lds
    s_mov_b32 m0, 139264
    s_nop 0
    buffer_load_dwordx4 v52, s[16:19], s34 offen lds
    s_mov_b32 m0, 140288
    s_nop 0
    buffer_load_dwordx4 v53, s[16:19], s34 offen lds
    s_mov_b32 m0, 141312
    s_nop 0
    buffer_load_dwordx4 v54, s[16:19], s34 offen lds
    s_mov_b32 m0, 142336
    s_nop 0
    buffer_load_dwordx4 v55, s[16:19], s34 offen lds
    s_mov_b32 m0, 143360
    s_nop 0
    buffer_load_dwordx4 v56, s[16:19], s34 offen lds
    s_mov_b32 m0, 144384
    s_nop 0
    buffer_load_dwordx4 v57, s[16:19], s34 offen lds
    s_mov_b32 m0, 145408
    s_nop 0
    buffer_load_dwordx4 v58, s[16:19], s34 offen lds
    s_mov_b32 m0, 146432
    s_nop 0
    buffer_load_dwordx4 v59, s[16:19], s34 offen lds
    s_waitcnt vmcnt(24)
    s_barrier
    s_waitcnt vmcnt(48)
    s_add_u32 s34, s35, 7077888
    s_mov_b32 m0, 147456
    s_nop 0
    buffer_load_dwordx4 v48, s[16:19], s34 offen lds
    s_mov_b32 m0, 148480
    s_nop 0
    buffer_load_dwordx4 v49, s[16:19], s34 offen lds
    s_mov_b32 m0, 149504
    s_nop 0
    buffer_load_dwordx4 v50, s[16:19], s34 offen lds
    s_mov_b32 m0, 150528
    s_nop 0
    buffer_load_dwordx4 v51, s[16:19], s34 offen lds
    s_mov_b32 m0, 151552
    s_nop 0
    buffer_load_dwordx4 v52, s[16:19], s34 offen lds
    s_mov_b32 m0, 152576
    s_nop 0
    buffer_load_dwordx4 v53, s[16:19], s34 offen lds
    s_mov_b32 m0, 153600
    s_nop 0
    buffer_load_dwordx4 v54, s[16:19], s34 offen lds
    s_mov_b32 m0, 154624
    s_nop 0
    buffer_load_dwordx4 v55, s[16:19], s34 offen lds
    s_mov_b32 m0, 155648
    s_nop 0
    buffer_load_dwordx4 v56, s[16:19], s34 offen lds
    s_mov_b32 m0, 156672
    s_nop 0
    buffer_load_dwordx4 v57, s[16:19], s34 offen lds
    s_mov_b32 m0, 157696
    s_nop 0
    buffer_load_dwordx4 v58, s[16:19], s34 offen lds
    s_mov_b32 m0, 158720
    s_nop 0
    buffer_load_dwordx4 v59, s[16:19], s34 offen lds
    s_waitcnt vmcnt(24)
    s_barrier
    s_waitcnt vmcnt(48)
    s_add_u32 s34, s35, 7471104
    s_mov_b32 m0, 110592
    s_nop 0
    buffer_load_dwordx4 v48, s[16:19], s34 offen lds
    s_mov_b32 m0, 111616
    s_nop 0
    buffer_load_dwordx4 v49, s[16:19], s34 offen lds
    s_mov_b32 m0, 112640
    s_nop 0
    buffer_load_dwordx4 v50, s[16:19], s34 offen lds
    s_mov_b32 m0, 113664
    s_nop 0
    buffer_load_dwordx4 v51, s[16:19], s34 offen lds
    s_mov_b32 m0, 114688
    s_nop 0
    buffer_load_dwordx4 v52, s[16:19], s34 offen lds
    s_mov_b32 m0, 115712
    s_nop 0
    buffer_load_dwordx4 v53, s[16:19], s34 offen lds
    s_mov_b32 m0, 116736
    s_nop 0
    buffer_load_dwordx4 v54, s[16:19], s34 offen lds
    s_mov_b32 m0, 117760
    s_nop 0
    buffer_load_dwordx4 v55, s[16:19], s34 offen lds
    s_mov_b32 m0, 118784
    s_nop 0
    buffer_load_dwordx4 v56, s[16:19], s34 offen lds
    s_mov_b32 m0, 119808
    s_nop 0
    buffer_load_dwordx4 v57, s[16:19], s34 offen lds
    s_mov_b32 m0, 120832
    s_nop 0
    buffer_load_dwordx4 v58, s[16:19], s34 offen lds
    s_mov_b32 m0, 121856
    s_nop 0
    buffer_load_dwordx4 v59, s[16:19], s34 offen lds
    s_waitcnt vmcnt(24)
    s_barrier
    s_waitcnt vmcnt(12)
    s_barrier
    s_waitcnt vmcnt(0)
    s_barrier
    s_barrier
    s_add_u32 m0, s31, 0
    s_nop 0
    buffer_load_dwordx4 v32, s[8:11], s29 offen nt lds
    s_add_u32 m0, s31, 1024
    s_nop 0
    buffer_load_dwordx4 v33, s[8:11], s29 offen nt lds
    s_add_u32 m0, s31, 2048
    s_nop 0
    buffer_load_dwordx4 v34, s[8:11], s29 offen nt lds
    s_add_u32 m0, s31, 3072
    s_nop 0
    buffer_load_dwordx4 v35, s[8:11], s29 offen nt lds
    s_add_u32 m0, s31, 4096
    s_nop 0
    buffer_load_dwordx4 v36, s[8:11], s29 offen nt lds
    s_add_u32 m0, s31, 5120
    s_nop 0
    buffer_load_dwordx4 v37, s[8:11], s29 offen nt lds
    s_add_u32 m0, s31, 6144
    s_nop 0
    buffer_load_dwordx4 v38, s[8:11], s29 offen nt lds
    s_add_u32 m0, s31, 7168
    s_nop 0
    buffer_load_dwordx4 v39, s[8:11], s29 offen nt lds
    s_add_u32 m0, s31, 8192
    s_nop 0
    buffer_load_dwordx4 v40, s[8:11], s29 offen nt lds
    s_add_u32 m0, s31, 9216
    s_nop 0
    buffer_load_dwordx4 v41, s[8:11], s29 offen nt lds
    s_add_u32 m0, s31, 10240
    s_nop 0
    buffer_load_dwordx4 v42, s[8:11], s29 offen nt lds
    s_add_u32 m0, s31, 11264
    s_nop 0
    buffer_load_dwordx4 v43, s[8:11], s29 offen nt lds
    s_add_u32 s29, s29, 12288
    s_add_u32 s31, s31, 12288
    s_cmp_eq_u32 s31, 122880
    s_cselect_b32 s31, 0, s31
    s_add_u32 s31, s31, 12288
    s_cmp_eq_u32 s31, 122880
    s_cselect_b32 s31, 0, s31
    s_add_u32 m0, s31, 0
    s_nop 0
    buffer_load_dwordx4 v32, s[8:11], s29 offen nt lds
    s_add_u32 m0, s31, 1024
    s_nop 0
    buffer_load_dwordx4 v33, s[8:11], s29 offen nt lds
    s_add_u32 m0, s31, 2048
    s_nop 0
    buffer_load_dwordx4 v34, s[8:11], s29 offen nt lds
    s_add_u32 m0, s31, 3072
    s_nop 0
    buffer_load_dwordx4 v35, s[8:11], s29 offen nt lds
    s_add_u32 m0, s31, 4096
    s_nop 0
    buffer_load_dwordx4 v36, s[8:11], s29 offen nt lds
    s_add_u32 m0, s31, 5120
    s_nop 0
    buffer_load_dwordx4 v37, s[8:11], s29 offen nt lds
    s_add_u32 m0, s31, 6144
    s_nop 0
    buffer_load_dwordx4 v38, s[8:11], s29 offen nt lds
    s_add_u32 m0, s31, 7168
    s_nop 0
    buffer_load_dwordx4 v39, s[8:11], s29 offen nt lds
    s_add_u32 m0, s31, 8192
    s_nop 0
    buffer_load_dwordx4 v40, s[8:11], s29 offen nt lds
    s_add_u32 m0, s31, 9216
    s_nop 0
    buffer_load_dwordx4 v41, s[8:11], s29 offen nt lds
    s_add_u32 m0, s31, 10240
    s_nop 0
    buffer_load_dwordx4 v42, s[8:11], s29 offen nt lds
    s_add_u32 m0, s31, 11264
    s_nop 0
    buffer_load_dwordx4 v43, s[8:11], s29 offen nt lds
    s_add_u32 s29, s29, 12288
    s_add_u32 s31, s31, 12288
    s_cmp_eq_u32 s31, 122880
    s_cselect_b32 s31, 0, s31
    s_add_u32 s31, s31, 12288
    s_cmp_eq_u32 s31, 122880
    s_cselect_b32 s31, 0, s31
    s_waitcnt vmcnt(48)
    s_barrier
    s_add_u32 m0, s31, 0
    s_nop 0
    buffer_load_dwordx4 v32, s[8:11], s29 offen nt lds
    s_add_u32 m0, s31, 1024
    s_nop 0
    buffer_load_dwordx4 v33, s[8:11], s29 offen nt lds
    s_add_u32 m0, s31, 2048
    s_nop 0
    buffer_load_dwordx4 v34, s[8:11], s29 offen nt lds
    s_add_u32 m0, s31, 3072
    s_nop 0
    buffer_load_dwordx4 v35, s[8:11], s29 offen nt lds
    s_add_u32 m0, s31, 4096
    s_nop 0
    buffer_load_dwordx4 v36, s[8:11], s29 offen nt lds
    s_add_u32 m0, s31, 5120
    s_nop 0
    buffer_load_dwordx4 v37, s[8:11], s29 offen nt lds
    s_add_u32 m0, s31, 6144
    s_nop 0
    buffer_load_dwordx4 v38, s[8:11], s29 offen nt lds
    s_add_u32 m0, s31, 7168
    s_nop 0
    buffer_load_dwordx4 v39, s[8:11], s29 offen nt lds
    s_add_u32 m0, s31, 8192
    s_nop 0
    buffer_load_dwordx4 v40, s[8:11], s29 offen nt lds
    s_add_u32 m0, s31, 9216
    s_nop 0
    buffer_load_dwordx4 v41, s[8:11], s29 offen nt lds
    s_add_u32 m0, s31, 10240
    s_nop 0
    buffer_load_dwordx4 v42, s[8:11], s29 offen nt lds
    s_add_u32 m0, s31, 11264
    s_nop 0
    buffer_load_dwordx4 v43, s[8:11], s29 offen nt lds
    s_add_u32 s29, s29, 12288
    s_add_u32 s31, s31, 12288
    s_cmp_eq_u32 s31, 122880
    s_cselect_b32 s31, 0, s31
    s_mov_b32 s34, 0
A_lK_1:
    s_waitcnt vmcnt(48)
    s_barrier
    s_add_u32 s31, s31, 12288
    s_cmp_eq_u32 s31, 122880
    s_cselect_b32 s31, 0, s31
    s_barrier
    s_add_u32 m0, s31, 0
    s_nop 0
    buffer_load_dwordx4 v32, s[8:11], s29 offen nt lds
    s_add_u32 m0, s31, 1024
    s_nop 0
    buffer_load_dwordx4 v33, s[8:11], s29 offen nt lds
    s_add_u32 m0, s31, 2048
    s_nop 0
    buffer_load_dwordx4 v34, s[8:11], s29 offen nt lds
    s_add_u32 m0, s31, 3072
    s_nop 0
    buffer_load_dwordx4 v35, s[8:11], s29 offen nt lds
    s_add_u32 m0, s31, 4096
    s_nop 0
    buffer_load_dwordx4 v36, s[8:11], s29 offen nt lds
    s_add_u32 m0, s31, 5120
    s_nop 0
    buffer_load_dwordx4 v37, s[8:11], s29 offen nt lds
    s_add_u32 m0, s31, 6144
    s_nop 0
    buffer_load_dwordx4 v38, s[8:11], s29 offen nt lds
    s_add_u32 m0, s31, 7168
    s_nop 0
    buffer_load_dwordx4 v39, s[8:11], s29 offen nt lds
    s_add_u32 m0, s31, 8192
    s_nop 0
    buffer_load_dwordx4 v40, s[8:11], s29 offen nt lds
    s_add_u32 m0, s31, 9216
    s_nop 0
    buffer_load_dwordx4 v41, s[8:11], s29 offen nt lds
    s_add_u32 m0, s31, 10240
    s_nop 0
    buffer_load_dwordx4 v42, s[8:11], s29 offen nt lds
    s_add_u32 m0, s31, 11264
    s_nop 0
    buffer_load_dwordx4 v43, s[8:11], s29 offen nt lds
    s_add_u32 s29, s29, 12288
    s_add_u32 s31, s31, 12288
    s_cmp_eq_u32 s31, 122880
    s_cselect_b32 s31, 0, s31
    s_add_u32 s34, s34, 1
    s_cmp_lt_u32 s34, 26
    s_cbranch_scc1 A_lK_1
    s_waitcnt vmcnt(48)
    s_barrier
    s_add_u32 s31, s31, 12288
    s_cmp_eq_u32 s31, 122880
    s_cselect_b32 s31, 0, s31
    s_barrier
    s_add_u32 s31, s31, 12288
    s_cmp_eq_u32 s31, 122880
    s_cselect_b32 s31, 0, s31
    s_waitcnt vmcnt(36)
    s_barrier
    s_add_u32 s29, s6, 100663296
    s_add_u32 m0, s31, 0
    s_nop 0
    buffer_load_dwordx4 v32, s[8:11], s29 offen nt lds
    s_add_u32 m0, s31, 1024
    s_nop 0
    buffer_load_dwordx4 v33, s[8:11], s29 offen nt lds
    s_add_u32 m0, s31, 2048
    s_nop 0
    buffer_load_dwordx4 v34, s[8:11], s29 offen nt lds
    s_add_u32 m0, s31, 3072
    s_nop 0
    buffer_load_dwordx4 v35, s[8:11], s29 offen nt lds
    s_add_u32 m0, s31, 4096
    s_nop 0
    buffer_load_dwordx4 v36, s[8:11], s29 offen nt lds
    s_add_u32 m0, s31, 5120
    s_nop 0
    buffer_load_dwordx4 v37, s[8:11], s29 offen nt lds
    s_add_u32 m0, s31, 6144
    s_nop 0
    buffer_load_dwordx4 v38, s[8:11], s29 offen nt lds
    s_add_u32 m0, s31, 7168
    s_nop 0
    buffer_load_dwordx4 v39, s[8:11], s29 offen nt lds
    s_add_u32 m0, s31, 8192
    s_nop 0
    buffer_load_dwordx4 v40, s[8:11], s29 offen nt lds
    s_add_u32 m0, s31, 9216
    s_nop 0
    buffer_load_dwordx4 v41, s[8:11], s29 offen nt lds
    s_add_u32 m0, s31, 10240
    s_nop 0
    buffer_load_dwordx4 v42, s[8:11], s29 offen nt lds
    s_add_u32 m0, s31, 11264
    s_nop 0
    buffer_load_dwordx4 v43, s[8:11], s29 offen nt lds
    s_add_u32 s29, s29, 12288
    s_add_u32 s31, s31, 12288
    s_cmp_eq_u32 s31, 122880
    s_cselect_b32 s31, 0, s31
    s_barrier
    s_add_u32 m0, s31, 0
    s_nop 0
    buffer_load_dwordx4 v32, s[8:11], s29 offen nt lds
    s_add_u32 m0, s31, 1024
    s_nop 0
    buffer_load_dwordx4 v33, s[8:11], s29 offen nt lds
    s_add_u32 m0, s31, 2048
    s_nop 0
    buffer_load_dwordx4 v34, s[8:11], s29 offen nt lds
    s_add_u32 m0, s31, 3072
    s_nop 0
    buffer_load_dwordx4 v35, s[8:11], s29 offen nt lds
    s_add_u32 m0, s31, 4096
    s_nop 0
    buffer_load_dwordx4 v36, s[8:11], s29 offen nt lds
    s_add_u32 m0, s31, 5120
    s_nop 0
    buffer_load_dwordx4 v37, s[8:11], s29 offen nt lds
    s_add_u32 m0, s31, 6144
    s_nop 0
    buffer_load_dwordx4 v38, s[8:11], s29 offen nt lds
    s_add_u32 m0, s31, 7168
    s_nop 0
    buffer_load_dwordx4 v39, s[8:11], s29 offen nt lds
    s_add_u32 m0, s31, 8192
    s_nop 0
    buffer_load_dwordx4 v40, s[8:11], s29 offen nt lds
    s_add_u32 m0, s31, 9216
    s_nop 0
    buffer_load_dwordx4 v41, s[8:11], s29 offen nt lds
    s_add_u32 m0, s31, 10240
    s_nop 0
    buffer_load_dwordx4 v42, s[8:11], s29 offen nt lds
    s_add_u32 m0, s31, 11264
    s_nop 0
    buffer_load_dwordx4 v43, s[8:11], s29 offen nt lds
    s_add_u32 s29, s29, 12288
    s_add_u32 s31, s31, 12288
    s_cmp_eq_u32 s31, 122880
    s_cselect_b32 s31, 0, s31
    s_waitcnt vmcnt(48)
    s_barrier
    s_add_u32 s31, s31, 12288
    s_cmp_eq_u32 s31, 122880
    s_cselect_b32 s31, 0, s31
    s_barrier
    s_add_u32 m0, s31, 0
    s_nop 0
    buffer_load_dwordx4 v32, s[8:11], s29 offen nt lds
    s_add_u32 m0, s31, 1024
    s_nop 0
    buffer_load_dwordx4 v33, s[8:11], s29 offen nt lds
    s_add_u32 m0, s31, 2048
    s_nop 0
    buffer_load_dwordx4 v34, s[8:11], s29 offen nt lds
    s_add_u32 m0, s31, 3072
    s_nop 0
    buffer_load_dwordx4 v35, s[8:11], s29 offen nt lds
    s_add_u32 m0, s31, 4096
    s_nop 0
    buffer_load_dwordx4 v36, s[8:11], s29 offen nt lds
    s_add_u32 m0, s31, 5120
    s_nop 0
    buffer_load_dwordx4 v37, s[8:11], s29 offen nt lds
    s_add_u32 m0, s31, 6144
    s_nop 0
    buffer_load_dwordx4 v38, s[8:11], s29 offen nt lds
    s_add_u32 m0, s31, 7168
    s_nop 0
    buffer_load_dwordx4 v39, s[8:11], s29 offen nt lds
    s_add_u32 m0, s31, 8192
    s_nop 0
    buffer_load_dwordx4 v40, s[8:11], s29 offen nt lds
    s_add_u32 m0, s31, 9216
    s_nop 0
    buffer_load_dwordx4 v41, s[8:11], s29 offen nt lds
    s_add_u32 m0, s31, 10240
    s_nop 0
    buffer_load_dwordx4 v42, s[8:11], s29 offen nt lds
    s_add_u32 m0, s31, 11264
    s_nop 0
    buffer_load_dwordx4 v43, s[8:11], s29 offen nt lds
    s_add_u32 s29, s29, 12288
    s_add_u32 s31, s31, 12288
    s_cmp_eq_u32 s31, 122880
    s_cselect_b32 s31, 0, s31
    s_waitcnt vmcnt(48)
    s_barrier
    s_add_u32 s31, s31, 12288
    s_cmp_eq_u32 s31, 122880
    s_cselect_b32 s31, 0, s31
    s_barrier
    s_add_u32 m0, s31, 0
    s_nop 0
    buffer_load_dwordx4 v32, s[8:11], s29 offen nt lds
    s_add_u32 m0, s31, 1024
    s_nop 0
    buffer_load_dwordx4 v33, s[8:11], s29 offen nt lds
    s_add_u32 m0, s31, 2048
    s_nop 0
    buffer_load_dwordx4 v34, s[8:11], s29 offen nt lds
    s_add_u32 m0, s31, 3072
    s_nop 0
    buffer_load_dwordx4 v35, s[8:11], s29 offen nt lds
    s_add_u32 m0, s31, 4096
    s_nop 0
    buffer_load_dwordx4 v36, s[8:11], s29 offen nt lds
    s_add_u32 m0, s31, 5120
    s_nop 0
    buffer_load_dwordx4 v37, s[8:11], s29 offen nt lds
    s_add_u32 m0, s31, 6144
    s_nop 0
    buffer_load_dwordx4 v38, s[8:11], s29 offen nt lds
    s_add_u32 m0, s31, 7168
    s_nop 0
    buffer_load_dwordx4 v39, s[8:11], s29 offen nt lds
    s_add_u32 m0, s31, 8192
    s_nop 0
    buffer_load_dwordx4 v40, s[8:11], s29 offen nt lds
    s_add_u32 m0, s31, 9216
    s_nop 0
    buffer_load_dwordx4 v41, s[8:11], s29 offen nt lds
    s_add_u32 m0, s31, 10240
    s_nop 0
    buffer_load_dwordx4 v42, s[8:11], s29 offen nt lds
    s_add_u32 m0, s31, 11264
    s_nop 0
    buffer_load_dwordx4 v43, s[8:11], s29 offen nt lds
    s_add_u32 s29, s29, 12288
    s_add_u32 s31, s31, 12288
    s_cmp_eq_u32 s31, 122880
    s_cselect_b32 s31, 0, s31
    s_waitcnt vmcnt(48)
    s_barrier
    s_add_u32 s31, s31, 12288
    s_cmp_eq_u32 s31, 122880
    s_cselect_b32 s31, 0, s31
    s_barrier
    s_add_u32 m0, s31, 0
    s_nop 0
    buffer_load_dwordx4 v32, s[8:11], s29 offen nt lds
    s_add_u32 m0, s31, 1024
    s_nop 0
    buffer_load_dwordx4 v33, s[8:11], s29 offen nt lds
    s_add_u32 m0, s31, 2048
    s_nop 0
    buffer_load_dwordx4 v34, s[8:11], s29 offen nt lds
    s_add_u32 m0, s31, 3072
    s_nop 0
    buffer_load_dwordx4 v35, s[8:11], s29 offen nt lds
    s_add_u32 m0, s31, 4096
    s_nop 0
    buffer_load_dwordx4 v36, s[8:11], s29 offen nt lds
    s_add_u32 m0, s31, 5120
    s_nop 0
    buffer_load_dwordx4 v37, s[8:11], s29 offen nt lds
    s_add_u32 m0, s31, 6144
    s_nop 0
    buffer_load_dwordx4 v38, s[8:11], s29 offen nt lds
    s_add_u32 m0, s31, 7168
    s_nop 0
    buffer_load_dwordx4 v39, s[8:11], s29 offen nt lds
    s_add_u32 m0, s31, 8192
    s_nop 0
    buffer_load_dwordx4 v40, s[8:11], s29 offen nt lds
    s_add_u32 m0, s31, 9216
    s_nop 0
    buffer_load_dwordx4 v41, s[8:11], s29 offen nt lds
    s_add_u32 m0, s31, 10240
    s_nop 0
    buffer_load_dwordx4 v42, s[8:11], s29 offen nt lds
    s_add_u32 m0, s31, 11264
    s_nop 0
    buffer_load_dwordx4 v43, s[8:11], s29 offen nt lds
    s_add_u32 s29, s29, 12288
    s_add_u32 s31, s31, 12288
    s_cmp_eq_u32 s31, 122880
    s_cselect_b32 s31, 0, s31
    s_barrier
    s_add_u32 s31, s31, 12288
    s_cmp_eq_u32 s31, 122880
    s_cselect_b32 s31, 0, s31
    s_waitcnt vmcnt(48)
    s_barrier
    s_add_u32 m0, s31, 0
    s_nop 0
    buffer_load_dwordx4 v32, s[8:11], s29 offen nt lds
    s_add_u32 m0, s31, 1024
    s_nop 0
    buffer_load_dwordx4 v33, s[8:11], s29 offen nt lds
    s_add_u32 m0, s31, 2048
    s_nop 0
    buffer_load_dwordx4 v34, s[8:11], s29 offen nt lds
    s_add_u32 m0, s31, 3072
    s_nop 0
    buffer_load_dwordx4 v35, s[8:11], s29 offen nt lds
    s_add_u32 m0, s31, 4096
    s_nop 0
    buffer_load_dwordx4 v36, s[8:11], s29 offen nt lds
    s_add_u32 m0, s31, 5120
    s_nop 0
    buffer_load_dwordx4 v37, s[8:11], s29 offen nt lds
    s_add_u32 m0, s31, 6144
    s_nop 0
    buffer_load_dwordx4 v38, s[8:11], s29 offen nt lds
    s_add_u32 m0, s31, 7168
    s_nop 0
    buffer_load_dwordx4 v39, s[8:11], s29 offen nt lds
    s_add_u32 m0, s31, 8192
    s_nop 0
    buffer_load_dwordx4 v40, s[8:11], s29 offen nt lds
    s_add_u32 m0, s31, 9216
    s_nop 0
    buffer_load_dwordx4 v41, s[8:11], s29 offen nt lds
    s_add_u32 m0, s31, 10240
    s_nop 0
    buffer_load_dwordx4 v42, s[8:11], s29 offen nt lds
    s_add_u32 m0, s31, 11264
    s_nop 0
    buffer_load_dwordx4 v43, s[8:11], s29 offen nt lds
    s_add_u32 s29, s29, 12288
    s_add_u32 s31, s31, 12288
    s_cmp_eq_u32 s31, 122880
    s_cselect_b32 s31, 0, s31
    s_mov_b32 s34, 0
A_lK_2:
    s_waitcnt vmcnt(48)
    s_barrier
    s_add_u32 s31, s31, 12288
    s_cmp_eq_u32 s31, 122880
    s_cselect_b32 s31, 0, s31
    s_barrier
    s_add_u32 m0, s31, 0
    s_nop 0
    buffer_load_dwordx4 v32, s[8:11], s29 offen nt lds
    s_add_u32 m0, s31, 1024
    s_nop 0
    buffer_load_dwordx4 v33, s[8:11], s29 offen nt lds
    s_add_u32 m0, s31, 2048
    s_nop 0
    buffer_load_dwordx4 v34, s[8:11], s29 offen nt lds
    s_add_u32 m0, s31, 3072
    s_nop 0
    buffer_load_dwordx4 v35, s[8:11], s29 offen nt lds
    s_add_u32 m0, s31, 4096
    s_nop 0
    buffer_load_dwordx4 v36, s[8:11], s29 offen nt lds
    s_add_u32 m0, s31, 5120
    s_nop 0
    buffer_load_dwordx4 v37, s[8:11], s29 offen nt lds
    s_add_u32 m0, s31, 6144
    s_nop 0
    buffer_load_dwordx4 v38, s[8:11], s29 offen nt lds
    s_add_u32 m0, s31, 7168
    s_nop 0
    buffer_load_dwordx4 v39, s[8:11], s29 offen nt lds
    s_add_u32 m0, s31, 8192
    s_nop 0
    buffer_load_dwordx4 v40, s[8:11], s29 offen nt lds
    s_add_u32 m0, s31, 9216
    s_nop 0
    buffer_load_dwordx4 v41, s[8:11], s29 offen nt lds
    s_add_u32 m0, s31, 10240
    s_nop 0
    buffer_load_dwordx4 v42, s[8:11], s29 offen nt lds
    s_add_u32 m0, s31, 11264
    s_nop 0
    buffer_load_dwordx4 v43, s[8:11], s29 offen nt lds
    s_add_u32 s29, s29, 12288
    s_add_u32 s31, s31, 12288
    s_cmp_eq_u32 s31, 122880
    s_cselect_b32 s31, 0, s31
    s_add_u32 s34, s34, 1
    s_cmp_lt_u32 s34, 26
    s_cbranch_scc1 A_lK_2
    s_waitcnt vmcnt(48)
    s_barrier
    s_add_u32 s31, s31, 12288
    s_cmp_eq_u32 s31, 122880
    s_cselect_b32 s31, 0, s31
    s_barrier
    s_add_u32 s31, s31, 12288
    s_cmp_eq_u32 s31, 122880
    s_cselect_b32 s31, 0, s31
    s_waitcnt vmcnt(36)
    s_barrier
    s_add_u32 s31, s31, 12288
    s_cmp_eq_u32 s31, 122880
    s_cselect_b32 s31, 0, s31
    s_barrier
    s_add_u32 s31, s31, 12288
    s_cmp_eq_u32 s31, 122880
    s_cselect_b32 s31, 0, s31
    s_waitcnt vmcnt(24)
    s_barrier
    s_add_u32 s31, s31, 12288
    s_cmp_eq_u32 s31, 122880
    s_cselect_b32 s31, 0, s31
    s_barrier
    s_add_u32 s31, s31, 12288
    s_cmp_eq_u32 s31, 122880
    s_cselect_b32 s31, 0, s31
    s_waitcnt vmcnt(12)
    s_barrier
    s_add_u32 s31, s31, 12288
    s_cmp_eq_u32 s31, 122880
    s_cselect_b32 s31, 0, s31
    s_barrier
    s_add_u32 s31, s31, 12288
    s_cmp_eq_u32 s31, 122880
    s_cselect_b32 s31, 0, s31
    s_waitcnt vmcnt(0)
    s_barrier
    s_add_u32 s31, s31, 12288
    s_cmp_eq_u32 s31, 122880
    s_cselect_b32 s31, 0, s31
    s_barrier
    s_add_u32 s31, s31, 12288
    s_cmp_eq_u32 s31, 122880
    s_cselect_b32 s31, 0, s31
    s_barrier
    s_add_u32 s31, s31, 12288
    s_cmp_eq_u32 s31, 122880
    s_cselect_b32 s31, 0, s31
    s_endpgm
A_loadV:
    s_setprio 3
    v_add_u32 v25, 0, v0
    v_mul_u32_u24 v26, 2731, v25
    v_lshrrev_b32 v26, 16, v26
    v_mul_u32_u24 v28, 24, v26
    v_sub_u32 v27, v25, v28
    v_bfe_u32 v28, v26, 1, 1
    v_lshlrev_b32 v28, 2, v28
    v_xor_b32 v29, v27, v28
    v_mul_u32_u24 v26, 384, v26
    v_lshl_add_u32 v32, v29, 4, v26
    v_add_u32 v25, 64, v0
    v_mul_u32_u24 v26, 2731, v25
    v_lshrrev_b32 v26, 16, v26
    v_mul_u32_u24 v28, 24, v26
    v_sub_u32 v27, v25, v28
    v_bfe_u32 v28, v26, 1, 1
    v_lshlrev_b32 v28, 2, v28
    v_xor_b32 v29, v27, v28
    v_mul_u32_u24 v26, 384, v26
    v_lshl_add_u32 v33, v29, 4, v26
    v_add_u32 v25, 128, v0
    v_mul_u32_u24 v26, 2731, v25
    v_lshrrev_b32 v26, 16, v26
    v_mul_u32_u24 v28, 24, v26
    v_sub_u32 v27, v25, v28
    v_bfe_u32 v28, v26, 1, 1
    v_lshlrev_b32 v28, 2, v28
    v_xor_b32 v29, v27, v28
    v_mul_u32_u24 v26, 384, v26
    v_lshl_add_u32 v34, v29, 4, v26
    v_add_u32 v25, 192, v0
    v_mul_u32_u24 v26, 2731, v25
    v_lshrrev_b32 v26, 16, v26
    v_mul_u32_u24 v28, 24, v26
    v_sub_u32 v27, v25, v28
    v_bfe_u32 v28, v26, 1, 1
    v_lshlrev_b32 v28, 2, v28
    v_xor_b32 v29, v27, v28
    v_mul_u32_u24 v26, 384, v26
    v_lshl_add_u32 v35, v29, 4, v26
    v_add_u32 v25, 256, v0
    v_mul_u32_u24 v26, 2731, v25
    v_lshrrev_b32 v26, 16, v26
    v_mul_u32_u24 v28, 24, v26
    v_sub_u32 v27, v25, v28
    v_bfe_u32 v28, v26, 1, 1
    v_lshlrev_b32 v28, 2, v28
    v_xor_b32 v29, v27, v28
    v_mul_u32_u24 v26, 384, v26
    v_lshl_add_u32 v36, v29, 4, v26
    v_add_u32 v25, 320, v0
    v_mul_u32_u24 v26, 2731, v25
    v_lshrrev_b32 v26, 16, v26
    v_mul_u32_u24 v28, 24, v26
    v_sub_u32 v27, v25, v28
    v_bfe_u32 v28, v26, 1, 1
    v_lshlrev_b32 v28, 2, v28
    v_xor_b32 v29, v27, v28
    v_mul_u32_u24 v26, 384, v26
    v_lshl_add_u32 v37, v29, 4, v26
    v_add_u32 v25, 384, v0
    v_mul_u32_u24 v26, 2731, v25
    v_lshrrev_b32 v26, 16, v26
    v_mul_u32_u24 v28, 24, v26
    v_sub_u32 v27, v25, v28
    v_bfe_u32 v28, v26, 1, 1
    v_lshlrev_b32 v28, 2, v28
    v_xor_b32 v29, v27, v28
    v_mul_u32_u24 v26, 384, v26
    v_lshl_add_u32 v38, v29, 4, v26
    v_add_u32 v25, 448, v0
    v_mul_u32_u24 v26, 2731, v25
    v_lshrrev_b32 v26, 16, v26
    v_mul_u32_u24 v28, 24, v26
    v_sub_u32 v27, v25, v28
    v_bfe_u32 v28, v26, 1, 1
    v_lshlrev_b32 v28, 2, v28
    v_xor_b32 v29, v27, v28
    v_mul_u32_u24 v26, 384, v26
    v_lshl_add_u32 v39, v29, 4, v26
    v_add_u32 v25, 512, v0
    v_mul_u32_u24 v26, 2731, v25
    v_lshrrev_b32 v26, 16, v26
    v_mul_u32_u24 v28, 24, v26
    v_sub_u32 v27, v25, v28
    v_bfe_u32 v28, v26, 1, 1
    v_lshlrev_b32 v28, 2, v28
    v_xor_b32 v29, v27, v28
    v_mul_u32_u24 v26, 384, v26
    v_lshl_add_u32 v40, v29, 4, v26
    v_add_u32 v25, 576, v0
    v_mul_u32_u24 v26, 2731, v25
    v_lshrrev_b32 v26, 16, v26
    v_mul_u32_u24 v28, 24, v26
    v_sub_u32 v27, v25, v28
    v_bfe_u32 v28, v26, 1, 1
    v_lshlrev_b32 v28, 2, v28
    v_xor_b32 v29, v27, v28
    v_mul_u32_u24 v26, 384, v26
    v_lshl_add_u32 v41, v29, 4, v26
    v_add_u32 v25, 640, v0
    v_mul_u32_u24 v26, 2731, v25
    v_lshrrev_b32 v26, 16, v26
    v_mul_u32_u24 v28, 24, v26
    v_sub_u32 v27, v25, v28
    v_bfe_u32 v28, v26, 1, 1
    v_lshlrev_b32 v28, 2, v28
    v_xor_b32 v29, v27, v28
    v_mul_u32_u24 v26, 384, v26
    v_lshl_add_u32 v42, v29, 4, v26
    v_add_u32 v25, 704, v0
    v_mul_u32_u24 v26, 2731, v25
    v_lshrrev_b32 v26, 16, v26
    v_mul_u32_u24 v28, 24, v26
    v_sub_u32 v27, v25, v28
    v_bfe_u32 v28, v26, 1, 1
    v_lshlrev_b32 v28, 2, v28
    v_xor_b32 v29, v27, v28
    v_mul_u32_u24 v26, 384, v26
    v_lshl_add_u32 v43, v29, 4, v26
    s_mov_b32 s29, s6
    s_mov_b32 s31, 0
    s_add_u32 s31, s31, 12288
    s_cmp_eq_u32 s31, 122880
    s_cselect_b32 s31, 0, s31
    s_add_u32 s31, s31, 12288
    s_cmp_eq_u32 s31, 122880
    s_cselect_b32 s31, 0, s31
    s_add_u32 m0, s31, 0
    s_nop 0
    buffer_load_dwordx4 v32, s[12:15], s29 offen nt lds
    s_add_u32 m0, s31, 1024
    s_nop 0
    buffer_load_dwordx4 v33, s[12:15], s29 offen nt lds
    s_add_u32 m0, s31, 2048
    s_nop 0
    buffer_load_dwordx4 v34, s[12:15], s29 offen nt lds
    s_add_u32 m0, s31, 3072
    s_nop 0
    buffer_load_dwordx4 v35, s[12:15], s29 offen nt lds
    s_add_u32 m0, s31, 4096
    s_nop 0
    buffer_load_dwordx4 v36, s[12:15], s29 offen nt lds
    s_add_u32 m0, s31, 5120
    s_nop 0
    buffer_load_dwordx4 v37, s[12:15], s29 offen nt lds
    s_add_u32 m0, s31, 6144
    s_nop 0
    buffer_load_dwordx4 v38, s[12:15], s29 offen nt lds
    s_add_u32 m0, s31, 7168
    s_nop 0
    buffer_load_dwordx4 v39, s[12:15], s29 offen nt lds
    s_add_u32 m0, s31, 8192
    s_nop 0
    buffer_load_dwordx4 v40, s[12:15], s29 offen nt lds
    s_add_u32 m0, s31, 9216
    s_nop 0
    buffer_load_dwordx4 v41, s[12:15], s29 offen nt lds
    s_add_u32 m0, s31, 10240
    s_nop 0
    buffer_load_dwordx4 v42, s[12:15], s29 offen nt lds
    s_add_u32 m0, s31, 11264
    s_nop 0
    buffer_load_dwordx4 v43, s[12:15], s29 offen nt lds
    s_add_u32 s29, s29, 12288
    s_add_u32 s31, s31, 12288
    s_cmp_eq_u32 s31, 122880
    s_cselect_b32 s31, 0, s31
    s_add_u32 s31, s31, 12288
    s_cmp_eq_u32 s31, 122880
    s_cselect_b32 s31, 0, s31
    s_add_u32 m0, s31, 0
    s_nop 0
    buffer_load_dwordx4 v32, s[12:15], s29 offen nt lds
    s_add_u32 m0, s31, 1024
    s_nop 0
    buffer_load_dwordx4 v33, s[12:15], s29 offen nt lds
    s_add_u32 m0, s31, 2048
    s_nop 0
    buffer_load_dwordx4 v34, s[12:15], s29 offen nt lds
    s_add_u32 m0, s31, 3072
    s_nop 0
    buffer_load_dwordx4 v35, s[12:15], s29 offen nt lds
    s_add_u32 m0, s31, 4096
    s_nop 0
    buffer_load_dwordx4 v36, s[12:15], s29 offen nt lds
    s_add_u32 m0, s31, 5120
    s_nop 0
    buffer_load_dwordx4 v37, s[12:15], s29 offen nt lds
    s_add_u32 m0, s31, 6144
    s_nop 0
    buffer_load_dwordx4 v38, s[12:15], s29 offen nt lds
    s_add_u32 m0, s31, 7168
    s_nop 0
    buffer_load_dwordx4 v39, s[12:15], s29 offen nt lds
    s_add_u32 m0, s31, 8192
    s_nop 0
    buffer_load_dwordx4 v40, s[12:15], s29 offen nt lds
    s_add_u32 m0, s31, 9216
    s_nop 0
    buffer_load_dwordx4 v41, s[12:15], s29 offen nt lds
    s_add_u32 m0, s31, 10240
    s_nop 0
    buffer_load_dwordx4 v42, s[12:15], s29 offen nt lds
    s_add_u32 m0, s31, 11264
    s_nop 0
    buffer_load_dwordx4 v43, s[12:15], s29 offen nt lds
    s_add_u32 s29, s29, 12288
    s_add_u32 s31, s31, 12288
    s_cmp_eq_u32 s31, 122880
    s_cselect_b32 s31, 0, s31
    v_add_u32 v25, 0, v0
    v_lshrrev_b32 v26, 3, v25
    v_and_b32 v27, 7, v25
    v_bfe_u32 v28, v26, 1, 3
    v_xor_b32 v27, v27, v28
    v_mul_u32_u24 v26, 1280, v26
    v_lshl_add_u32 v48, v27, 4, v26
    v_add_u32 v25, 64, v0
    v_lshrrev_b32 v26, 3, v25
    v_and_b32 v27, 7, v25
    v_bfe_u32 v28, v26, 1, 3
    v_xor_b32 v27, v27, v28
    v_mul_u32_u24 v26, 1280, v26
    v_lshl_add_u32 v49, v27, 4, v26
    v_add_u32 v25, 128, v0
    v_lshrrev_b32 v26, 3, v25
    v_and_b32 v27, 7, v25
    v_bfe_u32 v28, v26, 1, 3
    v_xor_b32 v27, v27, v28
    v_mul_u32_u24 v26, 1280, v26
    v_lshl_add_u32 v50, v27, 4, v26
    v_add_u32 v25, 192, v0
    v_lshrrev_b32 v26, 3, v25
    v_and_b32 v27, 7, v25
    v_bfe_u32 v28, v26, 1, 3
    v_xor_b32 v27, v27, v28
    v_mul_u32_u24 v26, 1280, v26
    v_lshl_add_u32 v51, v27, 4, v26
    v_add_u32 v25, 256, v0
    v_lshrrev_b32 v26, 3, v25
    v_and_b32 v27, 7, v25
    v_bfe_u32 v28, v26, 1, 3
    v_xor_b32 v27, v27, v28
    v_mul_u32_u24 v26, 1280, v26
    v_lshl_add_u32 v52, v27, 4, v26
    v_add_u32 v25, 320, v0
    v_lshrrev_b32 v26, 3, v25
    v_and_b32 v27, 7, v25
    v_bfe_u32 v28, v26, 1, 3
    v_xor_b32 v27, v27, v28
    v_mul_u32_u24 v26, 1280, v26
    v_lshl_add_u32 v53, v27, 4, v26
    v_add_u32 v25, 384, v0
    v_lshrrev_b32 v26, 3, v25
    v_and_b32 v27, 7, v25
    v_bfe_u32 v28, v26, 1, 3
    v_xor_b32 v27, v27, v28
    v_mul_u32_u24 v26, 1280, v26
    v_lshl_add_u32 v54, v27, 4, v26
    v_add_u32 v25, 448, v0
    v_lshrrev_b32 v26, 3, v25
    v_and_b32 v27, 7, v25
    v_bfe_u32 v28, v26, 1, 3
    v_xor_b32 v27, v27, v28
    v_mul_u32_u24 v26, 1280, v26
    v_lshl_add_u32 v55, v27, 4, v26
    v_add_u32 v25, 512, v0
    v_lshrrev_b32 v26, 3, v25
    v_and_b32 v27, 7, v25
    v_bfe_u32 v28, v26, 1, 3
    v_xor_b32 v27, v27, v28
    v_mul_u32_u24 v26, 1280, v26
    v_lshl_add_u32 v56, v27, 4, v26
    v_add_u32 v25, 576, v0
    v_lshrrev_b32 v26, 3, v25
    v_and_b32 v27, 7, v25
    v_bfe_u32 v28, v26, 1, 3
    v_xor_b32 v27, v27, v28
    v_mul_u32_u24 v26, 1280, v26
    v_lshl_add_u32 v57, v27, 4, v26
    v_add_u32 v25, 640, v0
    v_lshrrev_b32 v26, 3, v25
    v_and_b32 v27, 7, v25
    v_bfe_u32 v28, v26, 1, 3
    v_xor_b32 v27, v27, v28
    v_mul_u32_u24 v26, 1280, v26
    v_lshl_add_u32 v58, v27, 4, v26
    v_add_u32 v25, 704, v0
    v_lshrrev_b32 v26, 3, v25
    v_and_b32 v27, 7, v25
    v_bfe_u32 v28, v26, 1, 3
    v_xor_b32 v27, v27, v28
    v_mul_u32_u24 v26, 1280, v26
    v_lshl_add_u32 v59, v27, 4, v26
    v_add_u32 v25, 0, v0
    v_lshrrev_b32 v26, 3, v25
    v_and_b32 v27, 7, v25
    v_bfe_u32 v28, v26, 1, 3
    v_xor_b32 v27, v27, v28
    v_mul_u32_u24 v26, 1280, v26
    v_lshl_add_u32 v60, v27, 4, v26
    v_add_u32 v60, 983040, v60
    v_add_u32 v25, 64, v0
    v_lshrrev_b32 v26, 3, v25
    v_and_b32 v27, 7, v25
    v_bfe_u32 v28, v26, 1, 3
    v_xor_b32 v27, v27, v28
    v_mul_u32_u24 v26, 1280, v26
    v_lshl_add_u32 v61, v27, 4, v26
    v_add_u32 v61, 983040, v61
    v_add_u32 v25, 128, v0
    v_lshrrev_b32 v26, 3, v25
    v_and_b32 v27, 7, v25
    v_bfe_u32 v28, v26, 1, 3
    v_xor_b32 v27, v27, v28
    v_mul_u32_u24 v26, 1280, v26
    v_lshl_add_u32 v62, v27, 4, v26
    v_add_u32 v62, 983040, v62
    v_add_u32 v25, 192, v0
    v_lshrrev_b32 v26, 3, v25
    v_and_b32 v27, 7, v25
    v_bfe_u32 v28, v26, 1, 3
    v_xor_b32 v27, v27, v28
    v_mul_u32_u24 v26, 1280, v26
    v_lshl_add_u32 v63, v27, 4, v26
    v_add_u32 v63, 983040, v63
    v_add_u32 v25, 256, v0
    v_lshrrev_b32 v26, 3, v25
    v_and_b32 v27, 7, v25
    v_bfe_u32 v28, v26, 1, 3
    v_xor_b32 v27, v27, v28
    v_mul_u32_u24 v26, 1280, v26
    v_lshl_add_u32 v64, v27, 4, v26
    v_add_u32 v64, 983040, v64
    v_add_u32 v25, 320, v0
    v_lshrrev_b32 v26, 3, v25
    v_and_b32 v27, 7, v25
    v_bfe_u32 v28, v26, 1, 3
    v_xor_b32 v27, v27, v28
    v_mul_u32_u24 v26, 1280, v26
    v_lshl_add_u32 v65, v27, 4, v26
    v_add_u32 v65, 983040, v65
    v_add_u32 v25, 384, v0
    v_lshrrev_b32 v26, 3, v25
    v_and_b32 v27, 7, v25
    v_bfe_u32 v28, v26, 1, 3
    v_xor_b32 v27, v27, v28
    v_mul_u32_u24 v26, 1280, v26
    v_lshl_add_u32 v66, v27, 4, v26
    v_add_u32 v66, 983040, v66
    v_add_u32 v25, 448, v0
    v_lshrrev_b32 v26, 3, v25
    v_and_b32 v27, 7, v25
    v_bfe_u32 v28, v26, 1, 3
    v_xor_b32 v27, v27, v28
    v_mul_u32_u24 v26, 1280, v26
    v_lshl_add_u32 v67, v27, 4, v26
    v_add_u32 v67, 983040, v67
    v_add_u32 v25, 512, v0
    v_lshrrev_b32 v26, 3, v25
    v_and_b32 v27, 7, v25
    v_bfe_u32 v28, v26, 1, 3
    v_xor_b32 v27, v27, v28
    v_mul_u32_u24 v26, 1280, v26
    v_lshl_add_u32 v68, v27, 4, v26
    v_add_u32 v68, 983040, v68
    v_add_u32 v25, 576, v0
    v_lshrrev_b32 v26, 3, v25
    v_and_b32 v27, 7, v25
    v_bfe_u32 v28, v26, 1, 3
    v_xor_b32 v27, v27, v28
    v_mul_u32_u24 v26, 1280, v26
    v_lshl_add_u32 v69, v27, 4, v26
    v_add_u32 v69, 983040, v69
    v_add_u32 v25, 640, v0
    v_lshrrev_b32 v26, 3, v25
    v_and_b32 v27, 7, v25
    v_bfe_u32 v28, v26, 1, 3
    v_xor_b32 v27, v27, v28
    v_mul_u32_u24 v26, 1280, v26
    v_lshl_add_u32 v70, v27, 4, v26
    v_add_u32 v70, 983040, v70
    v_add_u32 v25, 704, v0
    v_lshrrev_b32 v26, 3, v25
    v_and_b32 v27, 7, v25
    v_bfe_u32 v28, v26, 1, 3
    v_xor_b32 v27, v27, v28
    v_mul_u32_u24 v26, 1280, v26
    v_lshl_add_u32 v71, v27, 4, v26
    v_add_u32 v71, 983040, v71
    s_mul_i32 s35, s4, 122880
    s_barrier
    s_barrier
    s_barrier
    s_waitcnt vmcnt(36)
    s_add_u32 s34, s35, 256
    s_mov_b32 m0, 61440
    s_nop 0
    buffer_load_dwordx4 v48, s[20:23], s34 offen lds
    s_mov_b32 m0, 62464
    s_nop 0
    buffer_load_dwordx4 v49, s[20:23], s34 offen lds
    s_mov_b32 m0, 63488
    s_nop 0
    buffer_load_dwordx4 v50, s[20:23], s34 offen lds
    s_mov_b32 m0, 64512
    s_nop 0
    buffer_load_dwordx4 v51, s[20:23], s34 offen lds
    s_mov_b32 m0, 65536
    s_nop 0
    buffer_load_dwordx4 v52, s[20:23], s34 offen lds
    s_mov_b32 m0, 66560
    s_nop 0
    buffer_load_dwordx4 v53, s[20:23], s34 offen lds
    s_mov_b32 m0, 67584
    s_nop 0
    buffer_load_dwordx4 v54, s[20:23], s34 offen lds
    s_mov_b32 m0, 68608
    s_nop 0
    buffer_load_dwordx4 v55, s[20:23], s34 offen lds
    s_mov_b32 m0, 69632
    s_nop 0
    buffer_load_dwordx4 v56, s[20:23], s34 offen lds
    s_mov_b32 m0, 70656
    s_nop 0
    buffer_load_dwordx4 v57, s[20:23], s34 offen lds
    s_mov_b32 m0, 71680
    s_nop 0
    buffer_load_dwordx4 v58, s[20:23], s34 offen lds
    s_mov_b32 m0, 72704
    s_nop 0
    buffer_load_dwordx4 v59, s[20:23], s34 offen lds
    s_mov_b32 m0, 73728
    s_nop 0
    buffer_load_dwordx4 v60, s[20:23], s34 offen lds
    s_mov_b32 m0, 74752
    s_nop 0
    buffer_load_dwordx4 v61, s[20:23], s34 offen lds
    s_mov_b32 m0, 75776
    s_nop 0
    buffer_load_dwordx4 v62, s[20:23], s34 offen lds
    s_mov_b32 m0, 76800
    s_nop 0
    buffer_load_dwordx4 v63, s[20:23], s34 offen lds
    s_mov_b32 m0, 77824
    s_nop 0
    buffer_load_dwordx4 v64, s[20:23], s34 offen lds
    s_mov_b32 m0, 78848
    s_nop 0
    buffer_load_dwordx4 v65, s[20:23], s34 offen lds
    s_mov_b32 m0, 79872
    s_nop 0
    buffer_load_dwordx4 v66, s[20:23], s34 offen lds
    s_mov_b32 m0, 80896
    s_nop 0
    buffer_load_dwordx4 v67, s[20:23], s34 offen lds
    s_mov_b32 m0, 81920
    s_nop 0
    buffer_load_dwordx4 v68, s[20:23], s34 offen lds
    s_mov_b32 m0, 82944
    s_nop 0
    buffer_load_dwordx4 v69, s[20:23], s34 offen lds
    s_mov_b32 m0, 83968
    s_nop 0
    buffer_load_dwordx4 v70, s[20:23], s34 offen lds
    s_mov_b32 m0, 84992
    s_nop 0
    buffer_load_dwordx4 v71, s[20:23], s34 offen lds
    s_barrier
    s_waitcnt vmcnt(0)
    s_barrier
    s_waitcnt vmcnt(36)
    s_add_u32 s34, s35, 384
    s_mov_b32 m0, 86016
    s_nop 0
    buffer_load_dwordx4 v48, s[20:23], s34 offen lds
    s_mov_b32 m0, 87040
    s_nop 0
    buffer_load_dwordx4 v49, s[20:23], s34 offen lds
    s_mov_b32 m0, 88064
    s_nop 0
    buffer_load_dwordx4 v50, s[20:23], s34 offen lds
    s_mov_b32 m0, 89088
    s_nop 0
    buffer_load_dwordx4 v51, s[20:23], s34 offen lds
    s_mov_b32 m0, 90112
    s_nop 0
    buffer_load_dwordx4 v52, s[20:23], s34 offen lds
    s_mov_b32 m0, 91136
    s_nop 0
    buffer_load_dwordx4 v53, s[20:23], s34 offen lds
    s_mov_b32 m0, 92160
    s_nop 0
    buffer_load_dwordx4 v54, s[20:23], s34 offen lds
    s_mov_b32 m0, 93184
    s_nop 0
    buffer_load_dwordx4 v55, s[20:23], s34 offen lds
    s_mov_b32 m0, 94208
    s_nop 0
    buffer_load_dwordx4 v56, s[20:23], s34 offen lds
    s_mov_b32 m0, 95232
    s_nop 0
    buffer_load_dwordx4 v57, s[20:23], s34 offen lds
    s_mov_b32 m0, 96256
    s_nop 0
    buffer_load_dwordx4 v58, s[20:23], s34 offen lds
    s_mov_b32 m0, 97280
    s_nop 0
    buffer_load_dwordx4 v59, s[20:23], s34 offen lds
    s_mov_b32 m0, 98304
    s_nop 0
    buffer_load_dwordx4 v60, s[20:23], s34 offen lds
    s_mov_b32 m0, 99328
    s_nop 0
    buffer_load_dwordx4 v61, s[20:23], s34 offen lds
    s_mov_b32 m0, 100352
    s_nop 0
    buffer_load_dwordx4 v62, s[20:23], s34 offen lds
    s_mov_b32 m0, 101376
    s_nop 0
    buffer_load_dwordx4 v63, s[20:23], s34 offen lds
    s_mov_b32 m0, 102400
    s_nop 0
    buffer_load_dwordx4 v64, s[20:23], s34 offen lds
    s_mov_b32 m0, 103424
    s_nop 0
    buffer_load_dwordx4 v65, s[20:23], s34 offen lds
    s_mov_b32 m0, 104448
    s_nop 0
    buffer_load_dwordx4 v66, s[20:23], s34 offen lds
    s_mov_b32 m0, 105472
    s_nop 0
    buffer_load_dwordx4 v67, s[20:23], s34 offen lds
    s_mov_b32 m0, 106496
    s_nop 0
    buffer_load_dwordx4 v68, s[20:23], s34 offen lds
    s_mov_b32 m0, 107520
    s_nop 0
    buffer_load_dwordx4 v69, s[20:23], s34 offen lds
    s_mov_b32 m0, 108544
    s_nop 0
    buffer_load_dwordx4 v70, s[20:23], s34 offen lds
    s_mov_b32 m0, 109568
    s_nop 0
    buffer_load_dwordx4 v71, s[20:23], s34 offen lds
    s_barrier
    s_waitcnt vmcnt(0)
    s_barrier
    s_waitcnt vmcnt(36)
    s_add_u32 s34, s35, 512
    s_mov_b32 m0, 61440
    s_nop 0
    buffer_load_dwordx4 v48, s[20:23], s34 offen lds
    s_mov_b32 m0, 62464
    s_nop 0
    buffer_load_dwordx4 v49, s[20:23], s34 offen lds
    s_mov_b32 m0, 63488
    s_nop 0
    buffer_load_dwordx4 v50, s[20:23], s34 offen lds
    s_mov_b32 m0, 64512
    s_nop 0
    buffer_load_dwordx4 v51, s[20:23], s34 offen lds
    s_mov_b32 m0, 65536
    s_nop 0
    buffer_load_dwordx4 v52, s[20:23], s34 offen lds
    s_mov_b32 m0, 66560
    s_nop 0
    buffer_load_dwordx4 v53, s[20:23], s34 offen lds
    s_mov_b32 m0, 67584
    s_nop 0
    buffer_load_dwordx4 v54, s[20:23], s34 offen lds
    s_mov_b32 m0, 68608
    s_nop 0
    buffer_load_dwordx4 v55, s[20:23], s34 offen lds
    s_mov_b32 m0, 69632
    s_nop 0
    buffer_load_dwordx4 v56, s[20:23], s34 offen lds
    s_mov_b32 m0, 70656
    s_nop 0
    buffer_load_dwordx4 v57, s[20:23], s34 offen lds
    s_mov_b32 m0, 71680
    s_nop 0
    buffer_load_dwordx4 v58, s[20:23], s34 offen lds
    s_mov_b32 m0, 72704
    s_nop 0
    buffer_load_dwordx4 v59, s[20:23], s34 offen lds
    s_mov_b32 m0, 73728
    s_nop 0
    buffer_load_dwordx4 v60, s[20:23], s34 offen lds
    s_mov_b32 m0, 74752
    s_nop 0
    buffer_load_dwordx4 v61, s[20:23], s34 offen lds
    s_mov_b32 m0, 75776
    s_nop 0
    buffer_load_dwordx4 v62, s[20:23], s34 offen lds
    s_mov_b32 m0, 76800
    s_nop 0
    buffer_load_dwordx4 v63, s[20:23], s34 offen lds
    s_mov_b32 m0, 77824
    s_nop 0
    buffer_load_dwordx4 v64, s[20:23], s34 offen lds
    s_mov_b32 m0, 78848
    s_nop 0
    buffer_load_dwordx4 v65, s[20:23], s34 offen lds
    s_mov_b32 m0, 79872
    s_nop 0
    buffer_load_dwordx4 v66, s[20:23], s34 offen lds
    s_mov_b32 m0, 80896
    s_nop 0
    buffer_load_dwordx4 v67, s[20:23], s34 offen lds
    s_mov_b32 m0, 81920
    s_nop 0
    buffer_load_dwordx4 v68, s[20:23], s34 offen lds
    s_mov_b32 m0, 82944
    s_nop 0
    buffer_load_dwordx4 v69, s[20:23], s34 offen lds
    s_mov_b32 m0, 83968
    s_nop 0
    buffer_load_dwordx4 v70, s[20:23], s34 offen lds
    s_mov_b32 m0, 84992
    s_nop 0
    buffer_load_dwordx4 v71, s[20:23], s34 offen lds
    s_barrier
    s_waitcnt vmcnt(0)
    s_barrier
    s_waitcnt vmcnt(36)
    s_add_u32 s34, s35, 640
    s_mov_b32 m0, 86016
    s_nop 0
    buffer_load_dwordx4 v48, s[20:23], s34 offen lds
    s_mov_b32 m0, 87040
    s_nop 0
    buffer_load_dwordx4 v49, s[20:23], s34 offen lds
    s_mov_b32 m0, 88064
    s_nop 0
    buffer_load_dwordx4 v50, s[20:23], s34 offen lds
    s_mov_b32 m0, 89088
    s_nop 0
    buffer_load_dwordx4 v51, s[20:23], s34 offen lds
    s_mov_b32 m0, 90112
    s_nop 0
    buffer_load_dwordx4 v52, s[20:23], s34 offen lds
    s_mov_b32 m0, 91136
    s_nop 0
    buffer_load_dwordx4 v53, s[20:23], s34 offen lds
    s_mov_b32 m0, 92160
    s_nop 0
    buffer_load_dwordx4 v54, s[20:23], s34 offen lds
    s_mov_b32 m0, 93184
    s_nop 0
    buffer_load_dwordx4 v55, s[20:23], s34 offen lds
    s_mov_b32 m0, 94208
    s_nop 0
    buffer_load_dwordx4 v56, s[20:23], s34 offen lds
    s_mov_b32 m0, 95232
    s_nop 0
    buffer_load_dwordx4 v57, s[20:23], s34 offen lds
    s_mov_b32 m0, 96256
    s_nop 0
    buffer_load_dwordx4 v58, s[20:23], s34 offen lds
    s_mov_b32 m0, 97280
    s_nop 0
    buffer_load_dwordx4 v59, s[20:23], s34 offen lds
    s_mov_b32 m0, 98304
    s_nop 0
    buffer_load_dwordx4 v60, s[20:23], s34 offen lds
    s_mov_b32 m0, 99328
    s_nop 0
    buffer_load_dwordx4 v61, s[20:23], s34 offen lds
    s_mov_b32 m0, 100352
    s_nop 0
    buffer_load_dwordx4 v62, s[20:23], s34 offen lds
    s_mov_b32 m0, 101376
    s_nop 0
    buffer_load_dwordx4 v63, s[20:23], s34 offen lds
    s_mov_b32 m0, 102400
    s_nop 0
    buffer_load_dwordx4 v64, s[20:23], s34 offen lds
    s_mov_b32 m0, 103424
    s_nop 0
    buffer_load_dwordx4 v65, s[20:23], s34 offen lds
    s_mov_b32 m0, 104448
    s_nop 0
    buffer_load_dwordx4 v66, s[20:23], s34 offen lds
    s_mov_b32 m0, 105472
    s_nop 0
    buffer_load_dwordx4 v67, s[20:23], s34 offen lds
    s_mov_b32 m0, 106496
    s_nop 0
    buffer_load_dwordx4 v68, s[20:23], s34 offen lds
    s_mov_b32 m0, 107520
    s_nop 0
    buffer_load_dwordx4 v69, s[20:23], s34 offen lds
    s_mov_b32 m0, 108544
    s_nop 0
    buffer_load_dwordx4 v70, s[20:23], s34 offen lds
    s_mov_b32 m0, 109568
    s_nop 0
    buffer_load_dwordx4 v71, s[20:23], s34 offen lds
    s_barrier
    s_waitcnt vmcnt(0)
    s_barrier
    s_waitcnt vmcnt(36)
    s_add_u32 s34, s35, 768
    s_mov_b32 m0, 61440
    s_nop 0
    buffer_load_dwordx4 v48, s[20:23], s34 offen lds
    s_mov_b32 m0, 62464
    s_nop 0
    buffer_load_dwordx4 v49, s[20:23], s34 offen lds
    s_mov_b32 m0, 63488
    s_nop 0
    buffer_load_dwordx4 v50, s[20:23], s34 offen lds
    s_mov_b32 m0, 64512
    s_nop 0
    buffer_load_dwordx4 v51, s[20:23], s34 offen lds
    s_mov_b32 m0, 65536
    s_nop 0
    buffer_load_dwordx4 v52, s[20:23], s34 offen lds
    s_mov_b32 m0, 66560
    s_nop 0
    buffer_load_dwordx4 v53, s[20:23], s34 offen lds
    s_mov_b32 m0, 67584
    s_nop 0
    buffer_load_dwordx4 v54, s[20:23], s34 offen lds
    s_mov_b32 m0, 68608
    s_nop 0
    buffer_load_dwordx4 v55, s[20:23], s34 offen lds
    s_mov_b32 m0, 69632
    s_nop 0
    buffer_load_dwordx4 v56, s[20:23], s34 offen lds
    s_mov_b32 m0, 70656
    s_nop 0
    buffer_load_dwordx4 v57, s[20:23], s34 offen lds
    s_mov_b32 m0, 71680
    s_nop 0
    buffer_load_dwordx4 v58, s[20:23], s34 offen lds
    s_mov_b32 m0, 72704
    s_nop 0
    buffer_load_dwordx4 v59, s[20:23], s34 offen lds
    s_mov_b32 m0, 73728
    s_nop 0
    buffer_load_dwordx4 v60, s[20:23], s34 offen lds
    s_mov_b32 m0, 74752
    s_nop 0
    buffer_load_dwordx4 v61, s[20:23], s34 offen lds
    s_mov_b32 m0, 75776
    s_nop 0
    buffer_load_dwordx4 v62, s[20:23], s34 offen lds
    s_mov_b32 m0, 76800
    s_nop 0
    buffer_load_dwordx4 v63, s[20:23], s34 offen lds
    s_mov_b32 m0, 77824
    s_nop 0
    buffer_load_dwordx4 v64, s[20:23], s34 offen lds
    s_mov_b32 m0, 78848
    s_nop 0
    buffer_load_dwordx4 v65, s[20:23], s34 offen lds
    s_mov_b32 m0, 79872
    s_nop 0
    buffer_load_dwordx4 v66, s[20:23], s34 offen lds
    s_mov_b32 m0, 80896
    s_nop 0
    buffer_load_dwordx4 v67, s[20:23], s34 offen lds
    s_mov_b32 m0, 81920
    s_nop 0
    buffer_load_dwordx4 v68, s[20:23], s34 offen lds
    s_mov_b32 m0, 82944
    s_nop 0
    buffer_load_dwordx4 v69, s[20:23], s34 offen lds
    s_mov_b32 m0, 83968
    s_nop 0
    buffer_load_dwordx4 v70, s[20:23], s34 offen lds
    s_mov_b32 m0, 84992
    s_nop 0
    buffer_load_dwordx4 v71, s[20:23], s34 offen lds
    s_barrier
    s_waitcnt vmcnt(0)
    s_barrier
    s_waitcnt vmcnt(36)
    s_add_u32 s34, s35, 896
    s_mov_b32 m0, 86016
    s_nop 0
    buffer_load_dwordx4 v48, s[20:23], s34 offen lds
    s_mov_b32 m0, 87040
    s_nop 0
    buffer_load_dwordx4 v49, s[20:23], s34 offen lds
    s_mov_b32 m0, 88064
    s_nop 0
    buffer_load_dwordx4 v50, s[20:23], s34 offen lds
    s_mov_b32 m0, 89088
    s_nop 0
    buffer_load_dwordx4 v51, s[20:23], s34 offen lds
    s_mov_b32 m0, 90112
    s_nop 0
    buffer_load_dwordx4 v52, s[20:23], s34 offen lds
    s_mov_b32 m0, 91136
    s_nop 0
    buffer_load_dwordx4 v53, s[20:23], s34 offen lds
    s_mov_b32 m0, 92160
    s_nop 0
    buffer_load_dwordx4 v54, s[20:23], s34 offen lds
    s_mov_b32 m0, 93184
    s_nop 0
    buffer_load_dwordx4 v55, s[20:23], s34 offen lds
    s_mov_b32 m0, 94208
    s_nop 0
    buffer_load_dwordx4 v56, s[20:23], s34 offen lds
    s_mov_b32 m0, 95232
    s_nop 0
    buffer_load_dwordx4 v57, s[20:23], s34 offen lds
    s_mov_b32 m0, 96256
    s_nop 0
    buffer_load_dwordx4 v58, s[20:23], s34 offen lds
    s_mov_b32 m0, 97280
    s_nop 0
    buffer_load_dwordx4 v59, s[20:23], s34 offen lds
    s_mov_b32 m0, 98304
    s_nop 0
    buffer_load_dwordx4 v60, s[20:23], s34 offen lds
    s_mov_b32 m0, 99328
    s_nop 0
    buffer_load_dwordx4 v61, s[20:23], s34 offen lds
    s_mov_b32 m0, 100352
    s_nop 0
    buffer_load_dwordx4 v62, s[20:23], s34 offen lds
    s_mov_b32 m0, 101376
    s_nop 0
    buffer_load_dwordx4 v63, s[20:23], s34 offen lds
    s_mov_b32 m0, 102400
    s_nop 0
    buffer_load_dwordx4 v64, s[20:23], s34 offen lds
    s_mov_b32 m0, 103424
    s_nop 0
    buffer_load_dwordx4 v65, s[20:23], s34 offen lds
    s_mov_b32 m0, 104448
    s_nop 0
    buffer_load_dwordx4 v66, s[20:23], s34 offen lds
    s_mov_b32 m0, 105472
    s_nop 0
    buffer_load_dwordx4 v67, s[20:23], s34 offen lds
    s_mov_b32 m0, 106496
    s_nop 0
    buffer_load_dwordx4 v68, s[20:23], s34 offen lds
    s_mov_b32 m0, 107520
    s_nop 0
    buffer_load_dwordx4 v69, s[20:23], s34 offen lds
    s_mov_b32 m0, 108544
    s_nop 0
    buffer_load_dwordx4 v70, s[20:23], s34 offen lds
    s_mov_b32 m0, 109568
    s_nop 0
    buffer_load_dwordx4 v71, s[20:23], s34 offen lds
    s_barrier
    s_waitcnt vmcnt(0)
    s_barrier
    s_waitcnt vmcnt(36)
    s_add_u32 s34, s35, 1024
    s_mov_b32 m0, 61440
    s_nop 0
    buffer_load_dwordx4 v48, s[20:23], s34 offen lds
    s_mov_b32 m0, 62464
    s_nop 0
    buffer_load_dwordx4 v49, s[20:23], s34 offen lds
    s_mov_b32 m0, 63488
    s_nop 0
    buffer_load_dwordx4 v50, s[20:23], s34 offen lds
    s_mov_b32 m0, 64512
    s_nop 0
    buffer_load_dwordx4 v51, s[20:23], s34 offen lds
    s_mov_b32 m0, 65536
    s_nop 0
    buffer_load_dwordx4 v52, s[20:23], s34 offen lds
    s_mov_b32 m0, 66560
    s_nop 0
    buffer_load_dwordx4 v53, s[20:23], s34 offen lds
    s_mov_b32 m0, 67584
    s_nop 0
    buffer_load_dwordx4 v54, s[20:23], s34 offen lds
    s_mov_b32 m0, 68608
    s_nop 0
    buffer_load_dwordx4 v55, s[20:23], s34 offen lds
    s_mov_b32 m0, 69632
    s_nop 0
    buffer_load_dwordx4 v56, s[20:23], s34 offen lds
    s_mov_b32 m0, 70656
    s_nop 0
    buffer_load_dwordx4 v57, s[20:23], s34 offen lds
    s_mov_b32 m0, 71680
    s_nop 0
    buffer_load_dwordx4 v58, s[20:23], s34 offen lds
    s_mov_b32 m0, 72704
    s_nop 0
    buffer_load_dwordx4 v59, s[20:23], s34 offen lds
    s_mov_b32 m0, 73728
    s_nop 0
    buffer_load_dwordx4 v60, s[20:23], s34 offen lds
    s_mov_b32 m0, 74752
    s_nop 0
    buffer_load_dwordx4 v61, s[20:23], s34 offen lds
    s_mov_b32 m0, 75776
    s_nop 0
    buffer_load_dwordx4 v62, s[20:23], s34 offen lds
    s_mov_b32 m0, 76800
    s_nop 0
    buffer_load_dwordx4 v63, s[20:23], s34 offen lds
    s_mov_b32 m0, 77824
    s_nop 0
    buffer_load_dwordx4 v64, s[20:23], s34 offen lds
    s_mov_b32 m0, 78848
    s_nop 0
    buffer_load_dwordx4 v65, s[20:23], s34 offen lds
    s_mov_b32 m0, 79872
    s_nop 0
    buffer_load_dwordx4 v66, s[20:23], s34 offen lds
    s_mov_b32 m0, 80896
    s_nop 0
    buffer_load_dwordx4 v67, s[20:23], s34 offen lds
    s_mov_b32 m0, 81920
    s_nop 0
    buffer_load_dwordx4 v68, s[20:23], s34 offen lds
    s_mov_b32 m0, 82944
    s_nop 0
    buffer_load_dwordx4 v69, s[20:23], s34 offen lds
    s_mov_b32 m0, 83968
    s_nop 0
    buffer_load_dwordx4 v70, s[20:23], s34 offen lds
    s_mov_b32 m0, 84992
    s_nop 0
    buffer_load_dwordx4 v71, s[20:23], s34 offen lds
    s_barrier
    s_waitcnt vmcnt(0)
    s_barrier
    s_waitcnt vmcnt(36)
    s_add_u32 s34, s35, 1152
    s_mov_b32 m0, 86016
    s_nop 0
    buffer_load_dwordx4 v48, s[20:23], s34 offen lds
    s_mov_b32 m0, 87040
    s_nop 0
    buffer_load_dwordx4 v49, s[20:23], s34 offen lds
    s_mov_b32 m0, 88064
    s_nop 0
    buffer_load_dwordx4 v50, s[20:23], s34 offen lds
    s_mov_b32 m0, 89088
    s_nop 0
    buffer_load_dwordx4 v51, s[20:23], s34 offen lds
    s_mov_b32 m0, 90112
    s_nop 0
    buffer_load_dwordx4 v52, s[20:23], s34 offen lds
    s_mov_b32 m0, 91136
    s_nop 0
    buffer_load_dwordx4 v53, s[20:23], s34 offen lds
    s_mov_b32 m0, 92160
    s_nop 0
    buffer_load_dwordx4 v54, s[20:23], s34 offen lds
    s_mov_b32 m0, 93184
    s_nop 0
    buffer_load_dwordx4 v55, s[20:23], s34 offen lds
    s_mov_b32 m0, 94208
    s_nop 0
    buffer_load_dwordx4 v56, s[20:23], s34 offen lds
    s_mov_b32 m0, 95232
    s_nop 0
    buffer_load_dwordx4 v57, s[20:23], s34 offen lds
    s_mov_b32 m0, 96256
    s_nop 0
    buffer_load_dwordx4 v58, s[20:23], s34 offen lds
    s_mov_b32 m0, 97280
    s_nop 0
    buffer_load_dwordx4 v59, s[20:23], s34 offen lds
    s_mov_b32 m0, 98304
    s_nop 0
    buffer_load_dwordx4 v60, s[20:23], s34 offen lds
    s_mov_b32 m0, 99328
    s_nop 0
    buffer_load_dwordx4 v61, s[20:23], s34 offen lds
    s_mov_b32 m0, 100352
    s_nop 0
    buffer_load_dwordx4 v62, s[20:23], s34 offen lds
    s_mov_b32 m0, 101376
    s_nop 0
    buffer_load_dwordx4 v63, s[20:23], s34 offen lds
    s_mov_b32 m0, 102400
    s_nop 0
    buffer_load_dwordx4 v64, s[20:23], s34 offen lds
    s_mov_b32 m0, 103424
    s_nop 0
    buffer_load_dwordx4 v65, s[20:23], s34 offen lds
    s_mov_b32 m0, 104448
    s_nop 0
    buffer_load_dwordx4 v66, s[20:23], s34 offen lds
    s_mov_b32 m0, 105472
    s_nop 0
    buffer_load_dwordx4 v67, s[20:23], s34 offen lds
    s_mov_b32 m0, 106496
    s_nop 0
    buffer_load_dwordx4 v68, s[20:23], s34 offen lds
    s_mov_b32 m0, 107520
    s_nop 0
    buffer_load_dwordx4 v69, s[20:23], s34 offen lds
    s_mov_b32 m0, 108544
    s_nop 0
    buffer_load_dwordx4 v70, s[20:23], s34 offen lds
    s_mov_b32 m0, 109568
    s_nop 0
    buffer_load_dwordx4 v71, s[20:23], s34 offen lds
    s_barrier
    s_waitcnt vmcnt(0)
    s_barrier
    s_barrier
    s_barrier
    s_add_u32 s31, s31, 12288
    s_cmp_eq_u32 s31, 122880
    s_cselect_b32 s31, 0, s31
    s_add_u32 m0, s31, 0
    s_nop 0
    buffer_load_dwordx4 v32, s[12:15], s29 offen nt lds
    s_add_u32 m0, s31, 1024
    s_nop 0
    buffer_load_dwordx4 v33, s[12:15], s29 offen nt lds
    s_add_u32 m0, s31, 2048
    s_nop 0
    buffer_load_dwordx4 v34, s[12:15], s29 offen nt lds
    s_add_u32 m0, s31, 3072
    s_nop 0
    buffer_load_dwordx4 v35, s[12:15], s29 offen nt lds
    s_add_u32 m0, s31, 4096
    s_nop 0
    buffer_load_dwordx4 v36, s[12:15], s29 offen nt lds
    s_add_u32 m0, s31, 5120
    s_nop 0
    buffer_load_dwordx4 v37, s[12:15], s29 offen nt lds
    s_add_u32 m0, s31, 6144
    s_nop 0
    buffer_load_dwordx4 v38, s[12:15], s29 offen nt lds
    s_add_u32 m0, s31, 7168
    s_nop 0
    buffer_load_dwordx4 v39, s[12:15], s29 offen nt lds
    s_add_u32 m0, s31, 8192
    s_nop 0
    buffer_load_dwordx4 v40, s[12:15], s29 offen nt lds
    s_add_u32 m0, s31, 9216
    s_nop 0
    buffer_load_dwordx4 v41, s[12:15], s29 offen nt lds
    s_add_u32 m0, s31, 10240
    s_nop 0
    buffer_load_dwordx4 v42, s[12:15], s29 offen nt lds
    s_add_u32 m0, s31, 11264
    s_nop 0
    buffer_load_dwordx4 v43, s[12:15], s29 offen nt lds
    s_add_u32 s29, s29, 12288
    s_add_u32 s31, s31, 12288
    s_cmp_eq_u32 s31, 122880
    s_cselect_b32 s31, 0, s31
    s_add_u32 s31, s31, 12288
    s_cmp_eq_u32 s31, 122880
    s_cselect_b32 s31, 0, s31
    s_add_u32 m0, s31, 0
    s_nop 0
    buffer_load_dwordx4 v32, s[12:15], s29 offen nt lds
    s_add_u32 m0, s31, 1024
    s_nop 0
    buffer_load_dwordx4 v33, s[12:15], s29 offen nt lds
    s_add_u32 m0, s31, 2048
    s_nop 0
    buffer_load_dwordx4 v34, s[12:15], s29 offen nt lds
    s_add_u32 m0, s31, 3072
    s_nop 0
    buffer_load_dwordx4 v35, s[12:15], s29 offen nt lds
    s_add_u32 m0, s31, 4096
    s_nop 0
    buffer_load_dwordx4 v36, s[12:15], s29 offen nt lds
    s_add_u32 m0, s31, 5120
    s_nop 0
    buffer_load_dwordx4 v37, s[12:15], s29 offen nt lds
    s_add_u32 m0, s31, 6144
    s_nop 0
    buffer_load_dwordx4 v38, s[12:15], s29 offen nt lds
    s_add_u32 m0, s31, 7168
    s_nop 0
    buffer_load_dwordx4 v39, s[12:15], s29 offen nt lds
    s_add_u32 m0, s31, 8192
    s_nop 0
    buffer_load_dwordx4 v40, s[12:15], s29 offen nt lds
    s_add_u32 m0, s31, 9216
    s_nop 0
    buffer_load_dwordx4 v41, s[12:15], s29 offen nt lds
    s_add_u32 m0, s31, 10240
    s_nop 0
    buffer_load_dwordx4 v42, s[12:15], s29 offen nt lds
    s_add_u32 m0, s31, 11264
    s_nop 0
    buffer_load_dwordx4 v43, s[12:15], s29 offen nt lds
    s_add_u32 s29, s29, 12288
    s_add_u32 s31, s31, 12288
    s_cmp_eq_u32 s31, 122880
    s_cselect_b32 s31, 0, s31
    s_barrier
    s_add_u32 s31, s31, 12288
    s_cmp_eq_u32 s31, 122880
    s_cselect_b32 s31, 0, s31
    s_mov_b32 s34, 0
A_lV_3:
    s_barrier
    s_add_u32 m0, s31, 0
    s_nop 0
    buffer_load_dwordx4 v32, s[12:15], s29 offen nt lds
    s_add_u32 m0, s31, 1024
    s_nop 0
    buffer_load_dwordx4 v33, s[12:15], s29 offen nt lds
    s_add_u32 m0, s31, 2048
    s_nop 0
    buffer_load_dwordx4 v34, s[12:15], s29 offen nt lds
    s_add_u32 m0, s31, 3072
    s_nop 0
    buffer_load_dwordx4 v35, s[12:15], s29 offen nt lds
    s_add_u32 m0, s31, 4096
    s_nop 0
    buffer_load_dwordx4 v36, s[12:15], s29 offen nt lds
    s_add_u32 m0, s31, 5120
    s_nop 0
    buffer_load_dwordx4 v37, s[12:15], s29 offen nt lds
    s_add_u32 m0, s31, 6144
    s_nop 0
    buffer_load_dwordx4 v38, s[12:15], s29 offen nt lds
    s_add_u32 m0, s31, 7168
    s_nop 0
    buffer_load_dwordx4 v39, s[12:15], s29 offen nt lds
    s_add_u32 m0, s31, 8192
    s_nop 0
    buffer_load_dwordx4 v40, s[12:15], s29 offen nt lds
    s_add_u32 m0, s31, 9216
    s_nop 0
    buffer_load_dwordx4 v41, s[12:15], s29 offen nt lds
    s_add_u32 m0, s31, 10240
    s_nop 0
    buffer_load_dwordx4 v42, s[12:15], s29 offen nt lds
    s_add_u32 m0, s31, 11264
    s_nop 0
    buffer_load_dwordx4 v43, s[12:15], s29 offen nt lds
    s_add_u32 s29, s29, 12288
    s_add_u32 s31, s31, 12288
    s_cmp_eq_u32 s31, 122880
    s_cselect_b32 s31, 0, s31
    s_waitcnt vmcnt(48)
    s_barrier
    s_add_u32 s31, s31, 12288
    s_cmp_eq_u32 s31, 122880
    s_cselect_b32 s31, 0, s31
    s_add_u32 s34, s34, 1
    s_cmp_lt_u32 s34, 26
    s_cbranch_scc1 A_lV_3
    s_barrier
    s_add_u32 m0, s31, 0
    s_nop 0
    buffer_load_dwordx4 v32, s[12:15], s29 offen nt lds
    s_add_u32 m0, s31, 1024
    s_nop 0
    buffer_load_dwordx4 v33, s[12:15], s29 offen nt lds
    s_add_u32 m0, s31, 2048
    s_nop 0
    buffer_load_dwordx4 v34, s[12:15], s29 offen nt lds
    s_add_u32 m0, s31, 3072
    s_nop 0
    buffer_load_dwordx4 v35, s[12:15], s29 offen nt lds
    s_add_u32 m0, s31, 4096
    s_nop 0
    buffer_load_dwordx4 v36, s[12:15], s29 offen nt lds
    s_add_u32 m0, s31, 5120
    s_nop 0
    buffer_load_dwordx4 v37, s[12:15], s29 offen nt lds
    s_add_u32 m0, s31, 6144
    s_nop 0
    buffer_load_dwordx4 v38, s[12:15], s29 offen nt lds
    s_add_u32 m0, s31, 7168
    s_nop 0
    buffer_load_dwordx4 v39, s[12:15], s29 offen nt lds
    s_add_u32 m0, s31, 8192
    s_nop 0
    buffer_load_dwordx4 v40, s[12:15], s29 offen nt lds
    s_add_u32 m0, s31, 9216
    s_nop 0
    buffer_load_dwordx4 v41, s[12:15], s29 offen nt lds
    s_add_u32 m0, s31, 10240
    s_nop 0
    buffer_load_dwordx4 v42, s[12:15], s29 offen nt lds
    s_add_u32 m0, s31, 11264
    s_nop 0
    buffer_load_dwordx4 v43, s[12:15], s29 offen nt lds
    s_add_u32 s29, s29, 12288
    s_add_u32 s31, s31, 12288
    s_cmp_eq_u32 s31, 122880
    s_cselect_b32 s31, 0, s31
    s_waitcnt vmcnt(48)
    s_barrier
    s_add_u32 m0, s31, 0
    s_nop 0
    buffer_load_dwordx4 v32, s[12:15], s29 offen nt lds
    s_add_u32 m0, s31, 1024
    s_nop 0
    buffer_load_dwordx4 v33, s[12:15], s29 offen nt lds
    s_add_u32 m0, s31, 2048
    s_nop 0
    buffer_load_dwordx4 v34, s[12:15], s29 offen nt lds
    s_add_u32 m0, s31, 3072
    s_nop 0
    buffer_load_dwordx4 v35, s[12:15], s29 offen nt lds
    s_add_u32 m0, s31, 4096
    s_nop 0
    buffer_load_dwordx4 v36, s[12:15], s29 offen nt lds
    s_add_u32 m0, s31, 5120
    s_nop 0
    buffer_load_dwordx4 v37, s[12:15], s29 offen nt lds
    s_add_u32 m0, s31, 6144
    s_nop 0
    buffer_load_dwordx4 v38, s[12:15], s29 offen nt lds
    s_add_u32 m0, s31, 7168
    s_nop 0
    buffer_load_dwordx4 v39, s[12:15], s29 offen nt lds
    s_add_u32 m0, s31, 8192
    s_nop 0
    buffer_load_dwordx4 v40, s[12:15], s29 offen nt lds
    s_add_u32 m0, s31, 9216
    s_nop 0
    buffer_load_dwordx4 v41, s[12:15], s29 offen nt lds
    s_add_u32 m0, s31, 10240
    s_nop 0
    buffer_load_dwordx4 v42, s[12:15], s29 offen nt lds
    s_add_u32 m0, s31, 11264
    s_nop 0
    buffer_load_dwordx4 v43, s[12:15], s29 offen nt lds
    s_add_u32 s29, s29, 12288
    s_add_u32 s31, s31, 12288
    s_cmp_eq_u32 s31, 122880
    s_cselect_b32 s31, 0, s31
    s_barrier
    s_add_u32 s31, s31, 12288
    s_cmp_eq_u32 s31, 122880
    s_cselect_b32 s31, 0, s31
    s_waitcnt vmcnt(48)
    s_barrier
    s_add_u32 s31, s31, 12288
    s_cmp_eq_u32 s31, 122880
    s_cselect_b32 s31, 0, s31
    s_barrier
    s_add_u32 s29, s6, 100663296
    s_add_u32 m0, s31, 0
    s_nop 0
    buffer_load_dwordx4 v32, s[12:15], s29 offen nt lds
    s_add_u32 m0, s31, 1024
    s_nop 0
    buffer_load_dwordx4 v33, s[12:15], s29 offen nt lds
    s_add_u32 m0, s31, 2048
    s_nop 0
    buffer_load_dwordx4 v34, s[12:15], s29 offen nt lds
    s_add_u32 m0, s31, 3072
    s_nop 0
    buffer_load_dwordx4 v35, s[12:15], s29 offen nt lds
    s_add_u32 m0, s31, 4096
    s_nop 0
    buffer_load_dwordx4 v36, s[12:15], s29 offen nt lds
    s_add_u32 m0, s31, 5120
    s_nop 0
    buffer_load_dwordx4 v37, s[12:15], s29 offen nt lds
    s_add_u32 m0, s31, 6144
    s_nop 0
    buffer_load_dwordx4 v38, s[12:15], s29 offen nt lds
    s_add_u32 m0, s31, 7168
    s_nop 0
    buffer_load_dwordx4 v39, s[12:15], s29 offen nt lds
    s_add_u32 m0, s31, 8192
    s_nop 0
    buffer_load_dwordx4 v40, s[12:15], s29 offen nt lds
    s_add_u32 m0, s31, 9216
    s_nop 0
    buffer_load_dwordx4 v41, s[12:15], s29 offen nt lds
    s_add_u32 m0, s31, 10240
    s_nop 0
    buffer_load_dwordx4 v42, s[12:15], s29 offen nt lds
    s_add_u32 m0, s31, 11264
    s_nop 0
    buffer_load_dwordx4 v43, s[12:15], s29 offen nt lds
    s_add_u32 s29, s29, 12288
    s_add_u32 s31, s31, 12288
    s_cmp_eq_u32 s31, 122880
    s_cselect_b32 s31, 0, s31
    s_waitcnt vmcnt(48)
    s_barrier
    s_add_u32 s31, s31, 12288
    s_cmp_eq_u32 s31, 122880
    s_cselect_b32 s31, 0, s31
    s_barrier
    s_add_u32 m0, s31, 0
    s_nop 0
    buffer_load_dwordx4 v32, s[12:15], s29 offen nt lds
    s_add_u32 m0, s31, 1024
    s_nop 0
    buffer_load_dwordx4 v33, s[12:15], s29 offen nt lds
    s_add_u32 m0, s31, 2048
    s_nop 0
    buffer_load_dwordx4 v34, s[12:15], s29 offen nt lds
    s_add_u32 m0, s31, 3072
    s_nop 0
    buffer_load_dwordx4 v35, s[12:15], s29 offen nt lds
    s_add_u32 m0, s31, 4096
    s_nop 0
    buffer_load_dwordx4 v36, s[12:15], s29 offen nt lds
    s_add_u32 m0, s31, 5120
    s_nop 0
    buffer_load_dwordx4 v37, s[12:15], s29 offen nt lds
    s_add_u32 m0, s31, 6144
    s_nop 0
    buffer_load_dwordx4 v38, s[12:15], s29 offen nt lds
    s_add_u32 m0, s31, 7168
    s_nop 0
    buffer_load_dwordx4 v39, s[12:15], s29 offen nt lds
    s_add_u32 m0, s31, 8192
    s_nop 0
    buffer_load_dwordx4 v40, s[12:15], s29 offen nt lds
    s_add_u32 m0, s31, 9216
    s_nop 0
    buffer_load_dwordx4 v41, s[12:15], s29 offen nt lds
    s_add_u32 m0, s31, 10240
    s_nop 0
    buffer_load_dwordx4 v42, s[12:15], s29 offen nt lds
    s_add_u32 m0, s31, 11264
    s_nop 0
    buffer_load_dwordx4 v43, s[12:15], s29 offen nt lds
    s_add_u32 s29, s29, 12288
    s_add_u32 s31, s31, 12288
    s_cmp_eq_u32 s31, 122880
    s_cselect_b32 s31, 0, s31
    s_waitcnt vmcnt(48)
    s_barrier
    s_add_u32 s31, s31, 12288
    s_cmp_eq_u32 s31, 122880
    s_cselect_b32 s31, 0, s31
    s_barrier
    s_add_u32 m0, s31, 0
    s_nop 0
    buffer_load_dwordx4 v32, s[12:15], s29 offen nt lds
    s_add_u32 m0, s31, 1024
    s_nop 0
    buffer_load_dwordx4 v33, s[12:15], s29 offen nt lds
    s_add_u32 m0, s31, 2048
    s_nop 0
    buffer_load_dwordx4 v34, s[12:15], s29 offen nt lds
    s_add_u32 m0, s31, 3072
    s_nop 0
    buffer_load_dwordx4 v35, s[12:15], s29 offen nt lds
    s_add_u32 m0, s31, 4096
    s_nop 0
    buffer_load_dwordx4 v36, s[12:15], s29 offen nt lds
    s_add_u32 m0, s31, 5120
    s_nop 0
    buffer_load_dwordx4 v37, s[12:15], s29 offen nt lds
    s_add_u32 m0, s31, 6144
    s_nop 0
    buffer_load_dwordx4 v38, s[12:15], s29 offen nt lds
    s_add_u32 m0, s31, 7168
    s_nop 0
    buffer_load_dwordx4 v39, s[12:15], s29 offen nt lds
    s_add_u32 m0, s31, 8192
    s_nop 0
    buffer_load_dwordx4 v40, s[12:15], s29 offen nt lds
    s_add_u32 m0, s31, 9216
    s_nop 0
    buffer_load_dwordx4 v41, s[12:15], s29 offen nt lds
    s_add_u32 m0, s31, 10240
    s_nop 0
    buffer_load_dwordx4 v42, s[12:15], s29 offen nt lds
    s_add_u32 m0, s31, 11264
    s_nop 0
    buffer_load_dwordx4 v43, s[12:15], s29 offen nt lds
    s_add_u32 s29, s29, 12288
    s_add_u32 s31, s31, 12288
    s_cmp_eq_u32 s31, 122880
    s_cselect_b32 s31, 0, s31
    s_waitcnt vmcnt(48)
    s_barrier
    s_add_u32 s31, s31, 12288
    s_cmp_eq_u32 s31, 122880
    s_cselect_b32 s31, 0, s31
    s_waitcnt vmcnt(36)
    s_barrier
    s_add_u32 m0, s31, 0
    s_nop 0
    buffer_load_dwordx4 v32, s[12:15], s29 offen nt lds
    s_add_u32 m0, s31, 1024
    s_nop 0
    buffer_load_dwordx4 v33, s[12:15], s29 offen nt lds
    s_add_u32 m0, s31, 2048
    s_nop 0
    buffer_load_dwordx4 v34, s[12:15], s29 offen nt lds
    s_add_u32 m0, s31, 3072
    s_nop 0
    buffer_load_dwordx4 v35, s[12:15], s29 offen nt lds
    s_add_u32 m0, s31, 4096
    s_nop 0
    buffer_load_dwordx4 v36, s[12:15], s29 offen nt lds
    s_add_u32 m0, s31, 5120
    s_nop 0
    buffer_load_dwordx4 v37, s[12:15], s29 offen nt lds
    s_add_u32 m0, s31, 6144
    s_nop 0
    buffer_load_dwordx4 v38, s[12:15], s29 offen nt lds
    s_add_u32 m0, s31, 7168
    s_nop 0
    buffer_load_dwordx4 v39, s[12:15], s29 offen nt lds
    s_add_u32 m0, s31, 8192
    s_nop 0
    buffer_load_dwordx4 v40, s[12:15], s29 offen nt lds
    s_add_u32 m0, s31, 9216
    s_nop 0
    buffer_load_dwordx4 v41, s[12:15], s29 offen nt lds
    s_add_u32 m0, s31, 10240
    s_nop 0
    buffer_load_dwordx4 v42, s[12:15], s29 offen nt lds
    s_add_u32 m0, s31, 11264
    s_nop 0
    buffer_load_dwordx4 v43, s[12:15], s29 offen nt lds
    s_add_u32 s29, s29, 12288
    s_add_u32 s31, s31, 12288
    s_cmp_eq_u32 s31, 122880
    s_cselect_b32 s31, 0, s31
    s_barrier
    s_add_u32 s31, s31, 12288
    s_cmp_eq_u32 s31, 122880
    s_cselect_b32 s31, 0, s31
    s_mov_b32 s34, 0
A_lV_4:
    s_barrier
    s_add_u32 m0, s31, 0
    s_nop 0
    buffer_load_dwordx4 v32, s[12:15], s29 offen nt lds
    s_add_u32 m0, s31, 1024
    s_nop 0
    buffer_load_dwordx4 v33, s[12:15], s29 offen nt lds
    s_add_u32 m0, s31, 2048
    s_nop 0
    buffer_load_dwordx4 v34, s[12:15], s29 offen nt lds
    s_add_u32 m0, s31, 3072
    s_nop 0
    buffer_load_dwordx4 v35, s[12:15], s29 offen nt lds
    s_add_u32 m0, s31, 4096
    s_nop 0
    buffer_load_dwordx4 v36, s[12:15], s29 offen nt lds
    s_add_u32 m0, s31, 5120
    s_nop 0
    buffer_load_dwordx4 v37, s[12:15], s29 offen nt lds
    s_add_u32 m0, s31, 6144
    s_nop 0
    buffer_load_dwordx4 v38, s[12:15], s29 offen nt lds
    s_add_u32 m0, s31, 7168
    s_nop 0
    buffer_load_dwordx4 v39, s[12:15], s29 offen nt lds
    s_add_u32 m0, s31, 8192
    s_nop 0
    buffer_load_dwordx4 v40, s[12:15], s29 offen nt lds
    s_add_u32 m0, s31, 9216
    s_nop 0
    buffer_load_dwordx4 v41, s[12:15], s29 offen nt lds
    s_add_u32 m0, s31, 10240
    s_nop 0
    buffer_load_dwordx4 v42, s[12:15], s29 offen nt lds
    s_add_u32 m0, s31, 11264
    s_nop 0
    buffer_load_dwordx4 v43, s[12:15], s29 offen nt lds
    s_add_u32 s29, s29, 12288
    s_add_u32 s31, s31, 12288
    s_cmp_eq_u32 s31, 122880
    s_cselect_b32 s31, 0, s31
    s_waitcnt vmcnt(48)
    s_barrier
    s_add_u32 s31, s31, 12288
    s_cmp_eq_u32 s31, 122880
    s_cselect_b32 s31, 0, s31
    s_add_u32 s34, s34, 1
    s_cmp_lt_u32 s34, 26
    s_cbranch_scc1 A_lV_4
    s_barrier
    s_add_u32 m0, s31, 0
    s_nop 0
    buffer_load_dwordx4 v32, s[12:15], s29 offen nt lds
    s_add_u32 m0, s31, 1024
    s_nop 0
    buffer_load_dwordx4 v33, s[12:15], s29 offen nt lds
    s_add_u32 m0, s31, 2048
    s_nop 0
    buffer_load_dwordx4 v34, s[12:15], s29 offen nt lds
    s_add_u32 m0, s31, 3072
    s_nop 0
    buffer_load_dwordx4 v35, s[12:15], s29 offen nt lds
    s_add_u32 m0, s31, 4096
    s_nop 0
    buffer_load_dwordx4 v36, s[12:15], s29 offen nt lds
    s_add_u32 m0, s31, 5120
    s_nop 0
    buffer_load_dwordx4 v37, s[12:15], s29 offen nt lds
    s_add_u32 m0, s31, 6144
    s_nop 0
    buffer_load_dwordx4 v38, s[12:15], s29 offen nt lds
    s_add_u32 m0, s31, 7168
    s_nop 0
    buffer_load_dwordx4 v39, s[12:15], s29 offen nt lds
    s_add_u32 m0, s31, 8192
    s_nop 0
    buffer_load_dwordx4 v40, s[12:15], s29 offen nt lds
    s_add_u32 m0, s31, 9216
    s_nop 0
    buffer_load_dwordx4 v41, s[12:15], s29 offen nt lds
    s_add_u32 m0, s31, 10240
    s_nop 0
    buffer_load_dwordx4 v42, s[12:15], s29 offen nt lds
    s_add_u32 m0, s31, 11264
    s_nop 0
    buffer_load_dwordx4 v43, s[12:15], s29 offen nt lds
    s_add_u32 s29, s29, 12288
    s_add_u32 s31, s31, 12288
    s_cmp_eq_u32 s31, 122880
    s_cselect_b32 s31, 0, s31
    s_waitcnt vmcnt(48)
    s_barrier
    s_add_u32 m0, s31, 0
    s_nop 0
    buffer_load_dwordx4 v32, s[12:15], s29 offen nt lds
    s_add_u32 m0, s31, 1024
    s_nop 0
    buffer_load_dwordx4 v33, s[12:15], s29 offen nt lds
    s_add_u32 m0, s31, 2048
    s_nop 0
    buffer_load_dwordx4 v34, s[12:15], s29 offen nt lds
    s_add_u32 m0, s31, 3072
    s_nop 0
    buffer_load_dwordx4 v35, s[12:15], s29 offen nt lds
    s_add_u32 m0, s31, 4096
    s_nop 0
    buffer_load_dwordx4 v36, s[12:15], s29 offen nt lds
    s_add_u32 m0, s31, 5120
    s_nop 0
    buffer_load_dwordx4 v37, s[12:15], s29 offen nt lds
    s_add_u32 m0, s31, 6144
    s_nop 0
    buffer_load_dwordx4 v38, s[12:15], s29 offen nt lds
    s_add_u32 m0, s31, 7168
    s_nop 0
    buffer_load_dwordx4 v39, s[12:15], s29 offen nt lds
    s_add_u32 m0, s31, 8192
    s_nop 0
    buffer_load_dwordx4 v40, s[12:15], s29 offen nt lds
    s_add_u32 m0, s31, 9216
    s_nop 0
    buffer_load_dwordx4 v41, s[12:15], s29 offen nt lds
    s_add_u32 m0, s31, 10240
    s_nop 0
    buffer_load_dwordx4 v42, s[12:15], s29 offen nt lds
    s_add_u32 m0, s31, 11264
    s_nop 0
    buffer_load_dwordx4 v43, s[12:15], s29 offen nt lds
    s_add_u32 s29, s29, 12288
    s_add_u32 s31, s31, 12288
    s_cmp_eq_u32 s31, 122880
    s_cselect_b32 s31, 0, s31
    s_barrier
    s_add_u32 s31, s31, 12288
    s_cmp_eq_u32 s31, 122880
    s_cselect_b32 s31, 0, s31
    s_waitcnt vmcnt(48)
    s_barrier
    s_add_u32 s31, s31, 12288
    s_cmp_eq_u32 s31, 122880
    s_cselect_b32 s31, 0, s31
    s_barrier
    s_add_u32 s31, s31, 12288
    s_cmp_eq_u32 s31, 122880
    s_cselect_b32 s31, 0, s31
    s_waitcnt vmcnt(36)
    s_barrier
    s_add_u32 s31, s31, 12288
    s_cmp_eq_u32 s31, 122880
    s_cselect_b32 s31, 0, s31
    s_barrier
    s_add_u32 s31, s31, 12288
    s_cmp_eq_u32 s31, 122880
    s_cselect_b32 s31, 0, s31
    s_waitcnt vmcnt(24)
    s_barrier
    s_add_u32 s31, s31, 12288
    s_cmp_eq_u32 s31, 122880
    s_cselect_b32 s31, 0, s31
    s_barrier
    s_add_u32 s31, s31, 12288
    s_cmp_eq_u32 s31, 122880
    s_cselect_b32 s31, 0, s31
    s_waitcnt vmcnt(12)
    s_barrier
    s_add_u32 s31, s31, 12288
    s_cmp_eq_u32 s31, 122880
    s_cselect_b32 s31, 0, s31
    s_waitcnt vmcnt(0)
    s_barrier
    s_add_u32 s31, s31, 12288
    s_cmp_eq_u32 s31, 122880
    s_cselect_b32 s31, 0, s31
    s_endpgm
A_done:
    s_endpgm
.globl oproj_kernel
.p2align 8
.type oproj_kernel,@function
oproj_kernel:
    s_cmp_ge_u32 s2, 240
    s_cbranch_scc1 B_done
    s_load_dwordx4 s[36:39], s[0:1], 32
    s_load_dwordx4 s[40:43], s[0:1], 48
    v_lshrrev_b32 v1, 6, v0
    v_and_b32 v0, 63, v0
    s_and_b32 s4, s2, 7
    s_lshr_b32 s5, s2, 3
    v_readfirstlane_b32 s3, v1
    s_lshr_b32 s31, s4, 1
    s_and_b32 s4, s4, 1
    s_mul_i32 s4, s4, 30
    s_add_u32 s5, s5, s4
    s_mul_i32 s6, s5, 52
    s_lshr_b32 s6, s6, 8
    s_mul_i32 s7, s6, 5
    s_sub_u32 s7, s5, s7
    s_waitcnt lgkmcnt(0)
    s_mov_b32 s8, s36
    s_and_b32 s9, s37, 0xffff
    s_mov_b32 s10, 7864320
    s_mov_b32 s11, 0x00020000
    s_mov_b32 s12, s42
    s_and_b32 s13, s43, 0xffff
    s_mov_b32 s14, 18874368
    s_mov_b32 s15, 0x00020000
    s_mov_b32 s16, s38
    s_and_b32 s17, s39, 0xffff
    s_mov_b32 s18, 1966080
    s_mov_b32 s19, 0x00020000
    s_add_u32 s20, s42, 50331648
    s_addc_u32 s21, s43, 0
    s_and_b32 s21, s21, 0xffff
    s_mov_b32 s22, 15728640
    s_mov_b32 s23, 0x00020000
    s_mov_b32 s24, s40
    s_and_b32 s25, s41, 0xffff
    s_mov_b32 s26, 256
    s_mov_b32 s27, 0x00020000
    s_cmp_ge_u32 s3, 4
    s_cbranch_scc1 B_load
    s_and_b32 s28, s3, 1
    s_lshr_b32 s29, s3, 1
    v_and_b32 v1, 31, v0
    v_lshrrev_b32 v2, 5, v0
    v_and_b32 v3, 15, v0
    v_bfe_u32 v4, v0, 4, 1
    v_lshrrev_b32 v5, 2, v3
    v_and_b32 v6, 3, v3
    v_lshl_add_u32 v25, v2, 3, v5
    v_lshlrev_b32 v25, 8, v25
    v_lshrrev_b32 v26, 1, v6
    v_lshl_add_u32 v26, v4, 1, v26
    v_lshl_add_u32 v25, v26, 4, v25
    v_and_b32 v26, 1, v6
    v_lshl_add_u32 v25, v26, 3, v25
    s_lshl_b32 s30, s28, 1
    s_add_u32 s33, s30, 0
    v_xor_b32 v26, s33, v5
    v_lshl_add_u32 v8, v26, 6, v25
    s_add_u32 s33, s30, 1
    v_xor_b32 v26, s33, v5
    v_lshl_add_u32 v9, v26, 6, v25
    s_lshl_b32 s30, s29, 12
    s_add_u32 s30, s30, 8192
    v_lshl_add_u32 v12, v0, 4, s30
    v_add_u32 v10, 65536, v8
    v_add_u32 v11, 65536, v9
    v_add_u32 v13, 65536, v12
    v_mov_b32 v80, 0
    v_mov_b32 v81, 0
    v_mov_b32 v82, 0
    v_mov_b32 v83, 0
    v_mov_b32 v84, 0
    v_mov_b32 v85, 0
    v_mov_b32 v86, 0
    v_mov_b32 v87, 0
    v_mov_b32 v88, 0
    v_mov_b32 v89, 0
    v_mov_b32 v90, 0
    v_mov_b32 v91, 0
    v_mov_b32 v92, 0
    v_mov_b32 v93, 0
    v_mov_b32 v94, 0
    v_mov_b32 v95, 0
    v_mov_b32 v96, 0
    v_mov_b32 v97, 0
    v_mov_b32 v98, 0
    v_mov_b32 v99, 0
    v_mov_b32 v100, 0
    v_mov_b32 v101, 0
    v_mov_b32 v102, 0
    v_mov_b32 v103, 0
    v_mov_b32 v104, 0
    v_mov_b32 v105, 0
    v_mov_b32 v106, 0
    v_mov_b32 v107, 0
    v_mov_b32 v108, 0
    v_mov_b32 v109, 0
    v_mov_b32 v110, 0
    v_mov_b32 v111, 0
    v_mov_b32 v112, 0
    v_mov_b32 v113, 0
    v_mov_b32 v114, 0
    v_mov_b32 v115, 0
    v_mov_b32 v116, 0
    v_mov_b32 v117, 0
    v_mov_b32 v118, 0
    v_mov_b32 v119, 0
    v_mov_b32 v120, 0
    v_mov_b32 v121, 0
    v_mov_b32 v122, 0
    v_mov_b32 v123, 0
    v_mov_b32 v124, 0
    v_mov_b32 v125, 0
    v_mov_b32 v126, 0
    v_mov_b32 v127, 0
    v_mov_b32 v128, 0
    v_mov_b32 v129, 0
    v_mov_b32 v130, 0
    v_mov_b32 v131, 0
    v_mov_b32 v132, 0
    v_mov_b32 v133, 0
    v_mov_b32 v134, 0
    v_mov_b32 v135, 0
    v_mov_b32 v136, 0
    v_mov_b32 v137, 0
    v_mov_b32 v138, 0
    v_mov_b32 v139, 0
    v_mov_b32 v140, 0
    v_mov_b32 v141, 0
    v_mov_b32 v142, 0
    v_mov_b32 v143, 0
    s_barrier
    ds_read_b64_tr_b16 v[16:17], v8 offset:0
    ds_read_b64_tr_b16 v[18:19], v8 offset:1024
    ds_read_b128 v[48:51], v12 offset:0
    ds_read_b64_tr_b16 v[20:21], v9 offset:0
    ds_read_b64_tr_b16 v[22:23], v9 offset:1024
    ds_read_b128 v[52:55], v12 offset:2048
    ds_read_b64_tr_b16 v[24:25], v8 offset:4096
    ds_read_b64_tr_b16 v[26:27], v8 offset:5120
    ds_read_b128 v[56:59], v12 offset:1024
    ds_read_b64_tr_b16 v[28:29], v9 offset:4096
    ds_read_b64_tr_b16 v[30:31], v9 offset:5120
    ds_read_b128 v[60:63], v12 offset:3072
    s_mov_b32 s34, 0
B_loop:
    s_waitcnt lgkmcnt(0)
    s_barrier
    v_mfma_f32_32x32x16_bf16 v[80:95], v[16:19], v[48:51], v[80:95]
    ds_read_b64_tr_b16 v[32:33], v8 offset:16384
    ds_read_b64_tr_b16 v[34:35], v8 offset:17408
    v_mfma_f32_32x32x16_bf16 v[96:111], v[16:19], v[52:55], v[96:111]
    ds_read_b128 v[64:67], v12 offset:16384
    v_mfma_f32_32x32x16_bf16 v[112:127], v[20:23], v[48:51], v[112:127]
    ds_read_b64_tr_b16 v[36:37], v9 offset:16384
    ds_read_b64_tr_b16 v[38:39], v9 offset:17408
    v_mfma_f32_32x32x16_bf16 v[128:143], v[20:23], v[52:55], v[128:143]
    ds_read_b128 v[68:71], v12 offset:18432
    v_mfma_f32_32x32x16_bf16 v[80:95], v[24:27], v[56:59], v[80:95]
    ds_read_b64_tr_b16 v[40:41], v8 offset:20480
    ds_read_b64_tr_b16 v[42:43], v8 offset:21504
    v_mfma_f32_32x32x16_bf16 v[96:111], v[24:27], v[60:63], v[96:111]
    ds_read_b128 v[72:75], v12 offset:17408
    v_mfma_f32_32x32x16_bf16 v[112:127], v[28:31], v[56:59], v[112:127]
    ds_read_b64_tr_b16 v[44:45], v9 offset:20480
    ds_read_b64_tr_b16 v[46:47], v9 offset:21504
    v_mfma_f32_32x32x16_bf16 v[128:143], v[28:31], v[60:63], v[128:143]
    ds_read_b128 v[76:79], v12 offset:19456
    s_waitcnt lgkmcnt(0)
    s_barrier
    v_mfma_f32_32x32x16_bf16 v[80:95], v[32:35], v[64:67], v[80:95]
    ds_read_b64_tr_b16 v[16:17], v8 offset:32768
    ds_read_b64_tr_b16 v[18:19], v8 offset:33792
    v_mfma_f32_32x32x16_bf16 v[96:111], v[32:35], v[68:71], v[96:111]
    ds_read_b128 v[48:51], v12 offset:32768
    v_mfma_f32_32x32x16_bf16 v[112:127], v[36:39], v[64:67], v[112:127]
    ds_read_b64_tr_b16 v[20:21], v9 offset:32768
    ds_read_b64_tr_b16 v[22:23], v9 offset:33792
    v_mfma_f32_32x32x16_bf16 v[128:143], v[36:39], v[68:71], v[128:143]
    ds_read_b128 v[52:55], v12 offset:34816
    v_mfma_f32_32x32x16_bf16 v[80:95], v[40:43], v[72:75], v[80:95]
    ds_read_b64_tr_b16 v[24:25], v8 offset:36864
    ds_read_b64_tr_b16 v[26:27], v8 offset:37888
    v_mfma_f32_32x32x16_bf16 v[96:111], v[40:43], v[76:79], v[96:111]
    ds_read_b128 v[56:59], v12 offset:33792
    v_mfma_f32_32x32x16_bf16 v[112:127], v[44:47], v[72:75], v[112:127]
    ds_read_b64_tr_b16 v[28:29], v9 offset:36864
    ds_read_b64_tr_b16 v[30:31], v9 offset:37888
    v_mfma_f32_32x32x16_bf16 v[128:143], v[44:47], v[76:79], v[128:143]
    ds_read_b128 v[60:63], v12 offset:35840
    s_waitcnt lgkmcnt(0)
    s_barrier
    v_mfma_f32_32x32x16_bf16 v[80:95], v[16:19], v[48:51], v[80:95]
    ds_read_b64_tr_b16 v[32:33], v8 offset:49152
    ds_read_b64_tr_b16 v[34:35], v8 offset:50176
    v_mfma_f32_32x32x16_bf16 v[96:111], v[16:19], v[52:55], v[96:111]
    ds_read_b128 v[64:67], v12 offset:49152
    v_mfma_f32_32x32x16_bf16 v[112:127], v[20:23], v[48:51], v[112:127]
    ds_read_b64_tr_b16 v[36:37], v9 offset:49152
    ds_read_b64_tr_b16 v[38:39], v9 offset:50176
    v_mfma_f32_32x32x16_bf16 v[128:143], v[20:23], v[52:55], v[128:143]
    ds_read_b128 v[68:71], v12 offset:51200
    v_mfma_f32_32x32x16_bf16 v[80:95], v[24:27], v[56:59], v[80:95]
    ds_read_b64_tr_b16 v[40:41], v8 offset:53248
    ds_read_b64_tr_b16 v[42:43], v8 offset:54272
    v_mfma_f32_32x32x16_bf16 v[96:111], v[24:27], v[60:63], v[96:111]
    ds_read_b128 v[72:75], v12 offset:50176
    v_mfma_f32_32x32x16_bf16 v[112:127], v[28:31], v[56:59], v[112:127]
    ds_read_b64_tr_b16 v[44:45], v9 offset:53248
    ds_read_b64_tr_b16 v[46:47], v9 offset:54272
    v_mfma_f32_32x32x16_bf16 v[128:143], v[28:31], v[60:63], v[128:143]
    ds_read_b128 v[76:79], v12 offset:52224
    s_waitcnt lgkmcnt(0)
    s_barrier
    v_mfma_f32_32x32x16_bf16 v[80:95], v[32:35], v[64:67], v[80:95]
    ds_read_b64_tr_b16 v[16:17], v10 offset:0
    ds_read_b64_tr_b16 v[18:19], v10 offset:1024
    v_mfma_f32_32x32x16_bf16 v[96:111], v[32:35], v[68:71], v[96:111]
    ds_read_b128 v[48:51], v13 offset:0
    v_mfma_f32_32x32x16_bf16 v[112:127], v[36:39], v[64:67], v[112:127]
    ds_read_b64_tr_b16 v[20:21], v11 offset:0
    ds_read_b64_tr_b16 v[22:23], v11 offset:1024
    v_mfma_f32_32x32x16_bf16 v[128:143], v[36:39], v[68:71], v[128:143]
    ds_read_b128 v[52:55], v13 offset:2048
    v_mfma_f32_32x32x16_bf16 v[80:95], v[40:43], v[72:75], v[80:95]
    ds_read_b64_tr_b16 v[24:25], v10 offset:4096
    ds_read_b64_tr_b16 v[26:27], v10 offset:5120
    v_mfma_f32_32x32x16_bf16 v[96:111], v[40:43], v[76:79], v[96:111]
    ds_read_b128 v[56:59], v13 offset:1024
    v_mfma_f32_32x32x16_bf16 v[112:127], v[44:47], v[72:75], v[112:127]
    ds_read_b64_tr_b16 v[28:29], v11 offset:4096
    ds_read_b64_tr_b16 v[30:31], v11 offset:5120
    v_mfma_f32_32x32x16_bf16 v[128:143], v[44:47], v[76:79], v[128:143]
    ds_read_b128 v[60:63], v13 offset:3072
    s_waitcnt lgkmcnt(0)
    s_barrier
    v_mfma_f32_32x32x16_bf16 v[80:95], v[16:19], v[48:51], v[80:95]
    ds_read_b64_tr_b16 v[32:33], v10 offset:16384
    ds_read_b64_tr_b16 v[34:35], v10 offset:17408
    v_mfma_f32_32x32x16_bf16 v[96:111], v[16:19], v[52:55], v[96:111]
    ds_read_b128 v[64:67], v13 offset:16384
    v_mfma_f32_32x32x16_bf16 v[112:127], v[20:23], v[48:51], v[112:127]
    ds_read_b64_tr_b16 v[36:37], v11 offset:16384
    ds_read_b64_tr_b16 v[38:39], v11 offset:17408
    v_mfma_f32_32x32x16_bf16 v[128:143], v[20:23], v[52:55], v[128:143]
    ds_read_b128 v[68:71], v13 offset:18432
    v_mfma_f32_32x32x16_bf16 v[80:95], v[24:27], v[56:59], v[80:95]
    ds_read_b64_tr_b16 v[40:41], v10 offset:20480
    ds_read_b64_tr_b16 v[42:43], v10 offset:21504
    v_mfma_f32_32x32x16_bf16 v[96:111], v[24:27], v[60:63], v[96:111]
    ds_read_b128 v[72:75], v13 offset:17408
    v_mfma_f32_32x32x16_bf16 v[112:127], v[28:31], v[56:59], v[112:127]
    ds_read_b64_tr_b16 v[44:45], v11 offset:20480
    ds_read_b64_tr_b16 v[46:47], v11 offset:21504
    v_mfma_f32_32x32x16_bf16 v[128:143], v[28:31], v[60:63], v[128:143]
    ds_read_b128 v[76:79], v13 offset:19456
    s_waitcnt lgkmcnt(0)
    s_barrier
    v_mfma_f32_32x32x16_bf16 v[80:95], v[32:35], v[64:67], v[80:95]
    ds_read_b64_tr_b16 v[16:17], v10 offset:32768
    ds_read_b64_tr_b16 v[18:19], v10 offset:33792
    v_mfma_f32_32x32x16_bf16 v[96:111], v[32:35], v[68:71], v[96:111]
    ds_read_b128 v[48:51], v13 offset:32768
    v_mfma_f32_32x32x16_bf16 v[112:127], v[36:39], v[64:67], v[112:127]
    ds_read_b64_tr_b16 v[20:21], v11 offset:32768
    ds_read_b64_tr_b16 v[22:23], v11 offset:33792
    v_mfma_f32_32x32x16_bf16 v[128:143], v[36:39], v[68:71], v[128:143]
    ds_read_b128 v[52:55], v13 offset:34816
    v_mfma_f32_32x32x16_bf16 v[80:95], v[40:43], v[72:75], v[80:95]
    ds_read_b64_tr_b16 v[24:25], v10 offset:36864
    ds_read_b64_tr_b16 v[26:27], v10 offset:37888
    v_mfma_f32_32x32x16_bf16 v[96:111], v[40:43], v[76:79], v[96:111]
    ds_read_b128 v[56:59], v13 offset:33792
    v_mfma_f32_32x32x16_bf16 v[112:127], v[44:47], v[72:75], v[112:127]
    ds_read_b64_tr_b16 v[28:29], v11 offset:36864
    ds_read_b64_tr_b16 v[30:31], v11 offset:37888
    v_mfma_f32_32x32x16_bf16 v[128:143], v[44:47], v[76:79], v[128:143]
    ds_read_b128 v[60:63], v13 offset:35840
    s_waitcnt lgkmcnt(0)
    s_barrier
    v_mfma_f32_32x32x16_bf16 v[80:95], v[16:19], v[48:51], v[80:95]
    ds_read_b64_tr_b16 v[32:33], v10 offset:49152
    ds_read_b64_tr_b16 v[34:35], v10 offset:50176
    v_mfma_f32_32x32x16_bf16 v[96:111], v[16:19], v[52:55], v[96:111]
    ds_read_b128 v[64:67], v13 offset:49152
    v_mfma_f32_32x32x16_bf16 v[112:127], v[20:23], v[48:51], v[112:127]
    ds_read_b64_tr_b16 v[36:37], v11 offset:49152
    ds_read_b64_tr_b16 v[38:39], v11 offset:50176
    v_mfma_f32_32x32x16_bf16 v[128:143], v[20:23], v[52:55], v[128:143]
    ds_read_b128 v[68:71], v13 offset:51200
    v_mfma_f32_32x32x16_bf16 v[80:95], v[24:27], v[56:59], v[80:95]
    ds_read_b64_tr_b16 v[40:41], v10 offset:53248
    ds_read_b64_tr_b16 v[42:43], v10 offset:54272
    v_mfma_f32_32x32x16_bf16 v[96:111], v[24:27], v[60:63], v[96:111]
    ds_read_b128 v[72:75], v13 offset:50176
    v_mfma_f32_32x32x16_bf16 v[112:127], v[28:31], v[56:59], v[112:127]
    ds_read_b64_tr_b16 v[44:45], v11 offset:53248
    ds_read_b64_tr_b16 v[46:47], v11 offset:54272
    v_mfma_f32_32x32x16_bf16 v[128:143], v[28:31], v[60:63], v[128:143]
    ds_read_b128 v[76:79], v13 offset:52224
    s_waitcnt lgkmcnt(0)
    s_barrier
    v_mfma_f32_32x32x16_bf16 v[80:95], v[32:35], v[64:67], v[80:95]
    ds_read_b64_tr_b16 v[16:17], v8 offset:0
    ds_read_b64_tr_b16 v[18:19], v8 offset:1024
    v_mfma_f32_32x32x16_bf16 v[96:111], v[32:35], v[68:71], v[96:111]
    ds_read_b128 v[48:51], v12 offset:0
    v_mfma_f32_32x32x16_bf16 v[112:127], v[36:39], v[64:67], v[112:127]
    ds_read_b64_tr_b16 v[20:21], v9 offset:0
    ds_read_b64_tr_b16 v[22:23], v9 offset:1024
    v_mfma_f32_32x32x16_bf16 v[128:143], v[36:39], v[68:71], v[128:143]
    ds_read_b128 v[52:55], v12 offset:2048
    v_mfma_f32_32x32x16_bf16 v[80:95], v[40:43], v[72:75], v[80:95]
    ds_read_b64_tr_b16 v[24:25], v8 offset:4096
    ds_read_b64_tr_b16 v[26:27], v8 offset:5120
    v_mfma_f32_32x32x16_bf16 v[96:111], v[40:43], v[76:79], v[96:111]
    ds_read_b128 v[56:59], v12 offset:1024
    v_mfma_f32_32x32x16_bf16 v[112:127], v[44:47], v[72:75], v[112:127]
    ds_read_b64_tr_b16 v[28:29], v9 offset:4096
    ds_read_b64_tr_b16 v[30:31], v9 offset:5120
    v_mfma_f32_32x32x16_bf16 v[128:143], v[44:47], v[76:79], v[128:143]
    ds_read_b128 v[60:63], v12 offset:3072
    s_add_u32 s34, s34, 1
    s_cmp_lt_u32 s34, 6
    s_cbranch_scc1 B_loop
    s_lshl_b32 s30, s5, 4
    s_lshl_b32 s33, s3, 2
    s_add_u32 s30, s30, s33
    v_lshlrev_b32 v9, 4, v0
    s_nop 7
    s_cmp_eq_u32 s3, s31
    s_cbranch_scc1 B_own
    s_add_u32 s33, s30, s31
    s_lshl_b32 s33, s33, 14
    buffer_store_dwordx4 v[80:83], v9, s[20:23], s33 offen offset:0 sc1
    buffer_store_dwordx4 v[84:87], v9, s[20:23], s33 offen offset:1024 sc1
    buffer_store_dwordx4 v[88:91], v9, s[20:23], s33 offen offset:2048 sc1
    buffer_store_dwordx4 v[92:95], v9, s[20:23], s33 offen offset:3072 sc1
    s_add_u32 s33, s33, 4096
    buffer_store_dwordx4 v[96:99], v9, s[20:23], s33 offen offset:0 sc1
    buffer_store_dwordx4 v[100:103], v9, s[20:23], s33 offen offset:1024 sc1
    buffer_store_dwordx4 v[104:107], v9, s[20:23], s33 offen offset:2048 sc1
    buffer_store_dwordx4 v[108:111], v9, s[20:23], s33 offen offset:3072 sc1
    s_add_u32 s33, s33, 4096
    buffer_store_dwordx4 v[112:115], v9, s[20:23], s33 offen offset:0 sc1
    buffer_store_dwordx4 v[116:119], v9, s[20:23], s33 offen offset:1024 sc1
    buffer_store_dwordx4 v[120:123], v9, s[20:23], s33 offen offset:2048 sc1
    buffer_store_dwordx4 v[124:127], v9, s[20:23], s33 offen offset:3072 sc1
    s_add_u32 s33, s33, 4096
    buffer_store_dwordx4 v[128:131], v9, s[20:23], s33 offen offset:0 sc1
    buffer_store_dwordx4 v[132:135], v9, s[20:23], s33 offen offset:1024 sc1
    buffer_store_dwordx4 v[136:139], v9, s[20:23], s33 offen offset:2048 sc1
    buffer_store_dwordx4 v[140:143], v9, s[20:23], s33 offen offset:3072 sc1
    s_waitcnt vmcnt(0)
    s_barrier
    s_endpgm
B_own:
    s_barrier
    s_lshl_b32 s33, s5, 2
    v_mov_b32 v10, s33
    v_mov_b32 v11, 1
    s_mov_b64 exec, 1
    buffer_atomic_add v11, v10, s[24:27], 0 offen
B_poll:
    buffer_load_dword v11, v10, s[24:27], 0 offen sc1
    s_waitcnt vmcnt(0)
    v_readfirstlane_b32 s35, v11
    s_cmp_ge_u32 s35, 4
    s_cbranch_scc1 B_go
    s_sleep 2
    s_branch B_poll
B_go:
    s_mov_b64 exec, -1
    s_add_u32 s33, s31, 1
    s_and_b32 s33, s33, 3
    s_add_u32 s33, s33, s30
    s_lshl_b32 s33, s33, 14
    buffer_load_dwordx4 v[144:147], v9, s[20:23], s33 offen offset:0 sc1
    buffer_load_dwordx4 v[148:151], v9, s[20:23], s33 offen offset:1024 sc1
    buffer_load_dwordx4 v[152:155], v9, s[20:23], s33 offen offset:2048 sc1
    buffer_load_dwordx4 v[156:159], v9, s[20:23], s33 offen offset:3072 sc1
    s_add_u32 s33, s33, 4096
    buffer_load_dwordx4 v[160:163], v9, s[20:23], s33 offen offset:0 sc1
    buffer_load_dwordx4 v[164:167], v9, s[20:23], s33 offen offset:1024 sc1
    buffer_load_dwordx4 v[168:171], v9, s[20:23], s33 offen offset:2048 sc1
    buffer_load_dwordx4 v[172:175], v9, s[20:23], s33 offen offset:3072 sc1
    s_add_u32 s33, s33, 4096
    buffer_load_dwordx4 v[176:179], v9, s[20:23], s33 offen offset:0 sc1
    buffer_load_dwordx4 v[180:183], v9, s[20:23], s33 offen offset:1024 sc1
    buffer_load_dwordx4 v[184:187], v9, s[20:23], s33 offen offset:2048 sc1
    buffer_load_dwordx4 v[188:191], v9, s[20:23], s33 offen offset:3072 sc1
    s_add_u32 s33, s33, 4096
    buffer_load_dwordx4 v[192:195], v9, s[20:23], s33 offen offset:0 sc1
    buffer_load_dwordx4 v[196:199], v9, s[20:23], s33 offen offset:1024 sc1
    buffer_load_dwordx4 v[200:203], v9, s[20:23], s33 offen offset:2048 sc1
    buffer_load_dwordx4 v[204:207], v9, s[20:23], s33 offen offset:3072 sc1
    s_add_u32 s33, s31, 2
    s_and_b32 s33, s33, 3
    s_add_u32 s33, s33, s30
    s_lshl_b32 s33, s33, 14
    buffer_load_dwordx4 v[16:19], v9, s[20:23], s33 offen offset:0 sc1
    buffer_load_dwordx4 v[20:23], v9, s[20:23], s33 offen offset:1024 sc1
    buffer_load_dwordx4 v[24:27], v9, s[20:23], s33 offen offset:2048 sc1
    buffer_load_dwordx4 v[28:31], v9, s[20:23], s33 offen offset:3072 sc1
    s_add_u32 s33, s33, 4096
    buffer_load_dwordx4 v[32:35], v9, s[20:23], s33 offen offset:0 sc1
    buffer_load_dwordx4 v[36:39], v9, s[20:23], s33 offen offset:1024 sc1
    buffer_load_dwordx4 v[40:43], v9, s[20:23], s33 offen offset:2048 sc1
    buffer_load_dwordx4 v[44:47], v9, s[20:23], s33 offen offset:3072 sc1
    s_add_u32 s33, s33, 4096
    buffer_load_dwordx4 v[48:51], v9, s[20:23], s33 offen offset:0 sc1
    buffer_load_dwordx4 v[52:55], v9, s[20:23], s33 offen offset:1024 sc1
    buffer_load_dwordx4 v[56:59], v9, s[20:23], s33 offen offset:2048 sc1
    buffer_load_dwordx4 v[60:63], v9, s[20:23], s33 offen offset:3072 sc1
    s_add_u32 s33, s33, 4096
    buffer_load_dwordx4 v[64:67], v9, s[20:23], s33 offen offset:0 sc1
    buffer_load_dwordx4 v[68:71], v9, s[20:23], s33 offen offset:1024 sc1
    buffer_load_dwordx4 v[72:75], v9, s[20:23], s33 offen offset:2048 sc1
    buffer_load_dwordx4 v[76:79], v9, s[20:23], s33 offen offset:3072 sc1
    s_waitcnt vmcnt(16)
    v_add_f32 v80, v80, v144
    v_add_f32 v81, v81, v145
    v_add_f32 v82, v82, v146
    v_add_f32 v83, v83, v147
    v_add_f32 v84, v84, v148
    v_add_f32 v85, v85, v149
    v_add_f32 v86, v86, v150
    v_add_f32 v87, v87, v151
    v_add_f32 v88, v88, v152
    v_add_f32 v89, v89, v153
    v_add_f32 v90, v90, v154
    v_add_f32 v91, v91, v155
    v_add_f32 v92, v92, v156
    v_add_f32 v93, v93, v157
    v_add_f32 v94, v94, v158
    v_add_f32 v95, v95, v159
    v_add_f32 v96, v96, v160
    v_add_f32 v97, v97, v161
    v_add_f32 v98, v98, v162
    v_add_f32 v99, v99, v163
    v_add_f32 v100, v100, v164
    v_add_f32 v101, v101, v165
    v_add_f32 v102, v102, v166
    v_add_f32 v103, v103, v167
    v_add_f32 v104, v104, v168
    v_add_f32 v105, v105, v169
    v_add_f32 v106, v106, v170
    v_add_f32 v107, v107, v171
    v_add_f32 v108, v108, v172
    v_add_f32 v109, v109, v173
    v_add_f32 v110, v110, v174
    v_add_f32 v111, v111, v175
    v_add_f32 v112, v112, v176
    v_add_f32 v113, v113, v177
    v_add_f32 v114, v114, v178
    v_add_f32 v115, v115, v179
    v_add_f32 v116, v116, v180
    v_add_f32 v117, v117, v181
    v_add_f32 v118, v118, v182
    v_add_f32 v119, v119, v183
    v_add_f32 v120, v120, v184
    v_add_f32 v121, v121, v185
    v_add_f32 v122, v122, v186
    v_add_f32 v123, v123, v187
    v_add_f32 v124, v124, v188
    v_add_f32 v125, v125, v189
    v_add_f32 v126, v126, v190
    v_add_f32 v127, v127, v191
    v_add_f32 v128, v128, v192
    v_add_f32 v129, v129, v193
    v_add_f32 v130, v130, v194
    v_add_f32 v131, v131, v195
    v_add_f32 v132, v132, v196
    v_add_f32 v133, v133, v197
    v_add_f32 v134, v134, v198
    v_add_f32 v135, v135, v199
    v_add_f32 v136, v136, v200
    v_add_f32 v137, v137, v201
    v_add_f32 v138, v138, v202
    v_add_f32 v139, v139, v203
    v_add_f32 v140, v140, v204
    v_add_f32 v141, v141, v205
    v_add_f32 v142, v142, v206
    v_add_f32 v143, v143, v207
    s_add_u32 s33, s31, 3
    s_and_b32 s33, s33, 3
    s_add_u32 s33, s33, s30
    s_lshl_b32 s33, s33, 14
    buffer_load_dwordx4 v[144:147], v9, s[20:23], s33 offen offset:0 sc1
    buffer_load_dwordx4 v[148:151], v9, s[20:23], s33 offen offset:1024 sc1
    buffer_load_dwordx4 v[152:155], v9, s[20:23], s33 offen offset:2048 sc1
    buffer_load_dwordx4 v[156:159], v9, s[20:23], s33 offen offset:3072 sc1
    s_add_u32 s33, s33, 4096
    buffer_load_dwordx4 v[160:163], v9, s[20:23], s33 offen offset:0 sc1
    buffer_load_dwordx4 v[164:167], v9, s[20:23], s33 offen offset:1024 sc1
    buffer_load_dwordx4 v[168:171], v9, s[20:23], s33 offen offset:2048 sc1
    buffer_load_dwordx4 v[172:175], v9, s[20:23], s33 offen offset:3072 sc1
    s_add_u32 s33, s33, 4096
    buffer_load_dwordx4 v[176:179], v9, s[20:23], s33 offen offset:0 sc1
    buffer_load_dwordx4 v[180:183], v9, s[20:23], s33 offen offset:1024 sc1
    buffer_load_dwordx4 v[184:187], v9, s[20:23], s33 offen offset:2048 sc1
    buffer_load_dwordx4 v[188:191], v9, s[20:23], s33 offen offset:3072 sc1
    s_add_u32 s33, s33, 4096
    buffer_load_dwordx4 v[192:195], v9, s[20:23], s33 offen offset:0 sc1
    buffer_load_dwordx4 v[196:199], v9, s[20:23], s33 offen offset:1024 sc1
    buffer_load_dwordx4 v[200:203], v9, s[20:23], s33 offen offset:2048 sc1
    buffer_load_dwordx4 v[204:207], v9, s[20:23], s33 offen offset:3072 sc1
    s_waitcnt vmcnt(16)
    v_add_f32 v80, v80, v16
    v_add_f32 v81, v81, v17
    v_add_f32 v82, v82, v18
    v_add_f32 v83, v83, v19
    v_add_f32 v84, v84, v20
    v_add_f32 v85, v85, v21
    v_add_f32 v86, v86, v22
    v_add_f32 v87, v87, v23
    v_add_f32 v88, v88, v24
    v_add_f32 v89, v89, v25
    v_add_f32 v90, v90, v26
    v_add_f32 v91, v91, v27
    v_add_f32 v92, v92, v28
    v_add_f32 v93, v93, v29
    v_add_f32 v94, v94, v30
    v_add_f32 v95, v95, v31
    v_add_f32 v96, v96, v32
    v_add_f32 v97, v97, v33
    v_add_f32 v98, v98, v34
    v_add_f32 v99, v99, v35
    v_add_f32 v100, v100, v36
    v_add_f32 v101, v101, v37
    v_add_f32 v102, v102, v38
    v_add_f32 v103, v103, v39
    v_add_f32 v104, v104, v40
    v_add_f32 v105, v105, v41
    v_add_f32 v106, v106, v42
    v_add_f32 v107, v107, v43
    v_add_f32 v108, v108, v44
    v_add_f32 v109, v109, v45
    v_add_f32 v110, v110, v46
    v_add_f32 v111, v111, v47
    v_add_f32 v112, v112, v48
    v_add_f32 v113, v113, v49
    v_add_f32 v114, v114, v50
    v_add_f32 v115, v115, v51
    v_add_f32 v116, v116, v52
    v_add_f32 v117, v117, v53
    v_add_f32 v118, v118, v54
    v_add_f32 v119, v119, v55
    v_add_f32 v120, v120, v56
    v_add_f32 v121, v121, v57
    v_add_f32 v122, v122, v58
    v_add_f32 v123, v123, v59
    v_add_f32 v124, v124, v60
    v_add_f32 v125, v125, v61
    v_add_f32 v126, v126, v62
    v_add_f32 v127, v127, v63
    v_add_f32 v128, v128, v64
    v_add_f32 v129, v129, v65
    v_add_f32 v130, v130, v66
    v_add_f32 v131, v131, v67
    v_add_f32 v132, v132, v68
    v_add_f32 v133, v133, v69
    v_add_f32 v134, v134, v70
    v_add_f32 v135, v135, v71
    v_add_f32 v136, v136, v72
    v_add_f32 v137, v137, v73
    v_add_f32 v138, v138, v74
    v_add_f32 v139, v139, v75
    v_add_f32 v140, v140, v76
    v_add_f32 v141, v141, v77
    v_add_f32 v142, v142, v78
    v_add_f32 v143, v143, v79
    s_waitcnt vmcnt(0)
    v_add_f32 v80, v80, v144
    v_add_f32 v81, v81, v145
    v_add_f32 v82, v82, v146
    v_add_f32 v83, v83, v147
    v_add_f32 v84, v84, v148
    v_add_f32 v85, v85, v149
    v_add_f32 v86, v86, v150
    v_add_f32 v87, v87, v151
    v_add_f32 v88, v88, v152
    v_add_f32 v89, v89, v153
    v_add_f32 v90, v90, v154
    v_add_f32 v91, v91, v155
    v_add_f32 v92, v92, v156
    v_add_f32 v93, v93, v157
    v_add_f32 v94, v94, v158
    v_add_f32 v95, v95, v159
    v_add_f32 v96, v96, v160
    v_add_f32 v97, v97, v161
    v_add_f32 v98, v98, v162
    v_add_f32 v99, v99, v163
    v_add_f32 v100, v100, v164
    v_add_f32 v101, v101, v165
    v_add_f32 v102, v102, v166
    v_add_f32 v103, v103, v167
    v_add_f32 v104, v104, v168
    v_add_f32 v105, v105, v169
    v_add_f32 v106, v106, v170
    v_add_f32 v107, v107, v171
    v_add_f32 v108, v108, v172
    v_add_f32 v109, v109, v173
    v_add_f32 v110, v110, v174
    v_add_f32 v111, v111, v175
    v_add_f32 v112, v112, v176
    v_add_f32 v113, v113, v177
    v_add_f32 v114, v114, v178
    v_add_f32 v115, v115, v179
    v_add_f32 v116, v116, v180
    v_add_f32 v117, v117, v181
    v_add_f32 v118, v118, v182
    v_add_f32 v119, v119, v183
    v_add_f32 v120, v120, v184
    v_add_f32 v121, v121, v185
    v_add_f32 v122, v122, v186
    v_add_f32 v123, v123, v187
    v_add_f32 v124, v124, v188
    v_add_f32 v125, v125, v189
    v_add_f32 v126, v126, v190
    v_add_f32 v127, v127, v191
    v_add_f32 v128, v128, v192
    v_add_f32 v129, v129, v193
    v_add_f32 v130, v130, v194
    v_add_f32 v131, v131, v195
    v_add_f32 v132, v132, v196
    v_add_f32 v133, v133, v197
    v_add_f32 v134, v134, v198
    v_add_f32 v135, v135, v199
    v_add_f32 v136, v136, v200
    v_add_f32 v137, v137, v201
    v_add_f32 v138, v138, v202
    v_add_f32 v139, v139, v203
    v_add_f32 v140, v140, v204
    v_add_f32 v141, v141, v205
    v_add_f32 v142, v142, v206
    v_add_f32 v143, v143, v207
    v_cvt_pk_bf16_f32 v144, v80, v81
    v_cvt_pk_bf16_f32 v145, v82, v83
    v_cvt_pk_bf16_f32 v146, v84, v85
    v_cvt_pk_bf16_f32 v147, v86, v87
    v_cvt_pk_bf16_f32 v148, v88, v89
    v_cvt_pk_bf16_f32 v149, v90, v91
    v_cvt_pk_bf16_f32 v150, v92, v93
    v_cvt_pk_bf16_f32 v151, v94, v95
    v_cvt_pk_bf16_f32 v152, v96, v97
    v_cvt_pk_bf16_f32 v153, v98, v99
    v_cvt_pk_bf16_f32 v154, v100, v101
    v_cvt_pk_bf16_f32 v155, v102, v103
    v_cvt_pk_bf16_f32 v156, v104, v105
    v_cvt_pk_bf16_f32 v157, v106, v107
    v_cvt_pk_bf16_f32 v158, v108, v109
    v_cvt_pk_bf16_f32 v159, v110, v111
    v_cvt_pk_bf16_f32 v160, v112, v113
    v_cvt_pk_bf16_f32 v161, v114, v115
    v_cvt_pk_bf16_f32 v162, v116, v117
    v_cvt_pk_bf16_f32 v163, v118, v119
    v_cvt_pk_bf16_f32 v164, v120, v121
    v_cvt_pk_bf16_f32 v165, v122, v123
    v_cvt_pk_bf16_f32 v166, v124, v125
    v_cvt_pk_bf16_f32 v167, v126, v127
    v_cvt_pk_bf16_f32 v168, v128, v129
    v_cvt_pk_bf16_f32 v169, v130, v131
    v_cvt_pk_bf16_f32 v170, v132, v133
    v_cvt_pk_bf16_f32 v171, v134, v135
    v_cvt_pk_bf16_f32 v172, v136, v137
    v_cvt_pk_bf16_f32 v173, v138, v139
    v_cvt_pk_bf16_f32 v174, v140, v141
    v_cvt_pk_bf16_f32 v175, v142, v143
    s_lshl_b32 s33, s6, 7
    s_lshl_b32 s35, s29, 6
    s_add_u32 s33, s33, s35
    v_add_u32 v9, s33, v1
    v_mul_u32_u24 v9, 1280, v9
    v_lshl_add_u32 v9, v2, 4, v9
    v_add_u32 v10, 40960, v9
    s_lshl_b32 s33, s7, 8
    s_lshl_b32 s35, s28, 7
    s_add_u32 s33, s33, s35
    v_permlane32_swap_b32 v144, v146
    v_permlane32_swap_b32 v145, v147
    v_permlane32_swap_b32 v148, v150
    v_permlane32_swap_b32 v149, v151
    v_permlane32_swap_b32 v152, v154
    v_permlane32_swap_b32 v153, v155
    v_permlane32_swap_b32 v156, v158
    v_permlane32_swap_b32 v157, v159
    v_permlane32_swap_b32 v160, v162
    v_permlane32_swap_b32 v161, v163
    v_permlane32_swap_b32 v164, v166
    v_permlane32_swap_b32 v165, v167
    v_permlane32_swap_b32 v168, v170
    v_permlane32_swap_b32 v169, v171
    v_permlane32_swap_b32 v172, v174
    v_permlane32_swap_b32 v173, v175
    buffer_store_dwordx4 v[144:147], v9, s[16:19], s33 offen offset:0
    buffer_store_dwordx4 v[148:151], v9, s[16:19], s33 offen offset:32
    buffer_store_dwordx4 v[152:155], v10, s[16:19], s33 offen offset:0
    buffer_store_dwordx4 v[156:159], v10, s[16:19], s33 offen offset:32
    buffer_store_dwordx4 v[160:163], v9, s[16:19], s33 offen offset:64
    buffer_store_dwordx4 v[164:167], v9, s[16:19], s33 offen offset:96
    buffer_store_dwordx4 v[168:171], v10, s[16:19], s33 offen offset:64
    buffer_store_dwordx4 v[172:175], v10, s[16:19], s33 offen offset:96
    s_endpgm
B_load:
    s_cmp_ge_u32 s3, 6
    s_cbranch_scc1 B_loado
    s_sub_u32 s28, s3, 4
    s_lshl_b32 s29, s28, 8
    v_add_u32 v25, s29, v0
    v_lshrrev_b32 v26, 4, v25
    v_and_b32 v27, 15, v25
    v_and_b32 v28, 3, v26
    v_lshlrev_b32 v28, 2, v28
    v_xor_b32 v27, v27, v28
    v_mul_u32_u24 v26, 1280, v26
    v_lshl_add_u32 v8, v27, 4, v26
    v_add_u32 v25, s29, v0
    v_add_u32 v25, 64, v25
    v_lshrrev_b32 v26, 4, v25
    v_and_b32 v27, 15, v25
    v_and_b32 v28, 3, v26
    v_lshlrev_b32 v28, 2, v28
    v_xor_b32 v27, v27, v28
    v_mul_u32_u24 v26, 1280, v26
    v_lshl_add_u32 v9, v27, 4, v26
    v_add_u32 v25, s29, v0
    v_add_u32 v25, 128, v25
    v_lshrrev_b32 v26, 4, v25
    v_and_b32 v27, 15, v25
    v_and_b32 v28, 3, v26
    v_lshlrev_b32 v28, 2, v28
    v_xor_b32 v27, v27, v28
    v_mul_u32_u24 v26, 1280, v26
    v_lshl_add_u32 v10, v27, 4, v26
    v_add_u32 v25, s29, v0
    v_add_u32 v25, 192, v25
    v_lshrrev_b32 v26, 4, v25
    v_and_b32 v27, 15, v25
    v_and_b32 v28, 3, v26
    v_lshlrev_b32 v28, 2, v28
    v_xor_b32 v27, v27, v28
    v_mul_u32_u24 v26, 1280, v26
    v_lshl_add_u32 v11, v27, 4, v26
    s_mul_i32 s33, s31, 1966080
    s_lshl_b32 s30, s7, 8
    s_add_u32 s33, s33, s30
    s_mov_b32 s35, 40960
    s_lshl_b32 s30, s28, 12
    s_mov_b32 s44, s8
    s_mov_b32 s45, s9
    s_mov_b32 s46, s10
    s_mov_b32 s47, s11
    s_branch B_lgo
B_loado:
    s_sub_u32 s28, s3, 6
    s_lshl_b32 s29, s6, 2
    s_lshl_b32 s30, s28, 1
    s_add_u32 s29, s29, s30
    s_mul_i32 s29, s29, 393216
    v_lshl_add_u32 v8, v0, 4, s29
    v_add_u32 v9, 1024, v8
    v_add_u32 v10, 393216, v8
    v_add_u32 v11, 394240, v8
    s_mul_i32 s33, s31, 98304
    s_mov_b32 s35, 2048
    s_lshl_b32 s30, s28, 12
    s_add_u32 s30, s30, 8192
    s_mov_b32 s44, s12
    s_mov_b32 s45, s13
    s_mov_b32 s46, s14
    s_mov_b32 s47, s15
B_lgo:
    s_add_u32 m0, s30, 0
    s_nop 0
    buffer_load_dwordx4 v8, s[44:47], s33 offen lds
    s_add_u32 m0, s30, 1024
    s_nop 0
    buffer_load_dwordx4 v9, s[44:47], s33 offen lds
    s_add_u32 m0, s30, 2048
    s_nop 0
    buffer_load_dwordx4 v10, s[44:47], s33 offen lds
    s_add_u32 m0, s30, 3072
    s_nop 0
    buffer_load_dwordx4 v11, s[44:47], s33 offen lds
    s_add_u32 s33, s33, s35
    s_add_u32 m0, s30, 16384
    s_nop 0
    buffer_load_dwordx4 v8, s[44:47], s33 offen lds
    s_add_u32 m0, s30, 17408
    s_nop 0
    buffer_load_dwordx4 v9, s[44:47], s33 offen lds
    s_add_u32 m0, s30, 18432
    s_nop 0
    buffer_load_dwordx4 v10, s[44:47], s33 offen lds
    s_add_u32 m0, s30, 19456
    s_nop 0
    buffer_load_dwordx4 v11, s[44:47], s33 offen lds
    s_add_u32 s33, s33, s35
    s_add_u32 m0, s30, 32768
    s_nop 0
    buffer_load_dwordx4 v8, s[44:47], s33 offen lds
    s_add_u32 m0, s30, 33792
    s_nop 0
    buffer_load_dwordx4 v9, s[44:47], s33 offen lds
    s_add_u32 m0, s30, 34816
    s_nop 0
    buffer_load_dwordx4 v10, s[44:47], s33 offen lds
    s_add_u32 m0, s30, 35840
    s_nop 0
    buffer_load_dwordx4 v11, s[44:47], s33 offen lds
    s_add_u32 s33, s33, s35
    s_add_u32 m0, s30, 49152
    s_nop 0
    buffer_load_dwordx4 v8, s[44:47], s33 offen lds
    s_add_u32 m0, s30, 50176
    s_nop 0
    buffer_load_dwordx4 v9, s[44:47], s33 offen lds
    s_add_u32 m0, s30, 51200
    s_nop 0
    buffer_load_dwordx4 v10, s[44:47], s33 offen lds
    s_add_u32 m0, s30, 52224
    s_nop 0
    buffer_load_dwordx4 v11, s[44:47], s33 offen lds
    s_add_u32 s33, s33, s35
    s_add_u32 m0, s30, 65536
    s_nop 0
    buffer_load_dwordx4 v8, s[44:47], s33 offen lds
    s_add_u32 m0, s30, 66560
    s_nop 0
    buffer_load_dwordx4 v9, s[44:47], s33 offen lds
    s_add_u32 m0, s30, 67584
    s_nop 0
    buffer_load_dwordx4 v10, s[44:47], s33 offen lds
    s_add_u32 m0, s30, 68608
    s_nop 0
    buffer_load_dwordx4 v11, s[44:47], s33 offen lds
    s_add_u32 s33, s33, s35
    s_add_u32 m0, s30, 81920
    s_nop 0
    buffer_load_dwordx4 v8, s[44:47], s33 offen lds
    s_add_u32 m0, s30, 82944
    s_nop 0
    buffer_load_dwordx4 v9, s[44:47], s33 offen lds
    s_add_u32 m0, s30, 83968
    s_nop 0
    buffer_load_dwordx4 v10, s[44:47], s33 offen lds
    s_add_u32 m0, s30, 84992
    s_nop 0
    buffer_load_dwordx4 v11, s[44:47], s33 offen lds
    s_add_u32 s33, s33, s35
    s_add_u32 m0, s30, 98304
    s_nop 0
    buffer_load_dwordx4 v8, s[44:47], s33 offen lds
    s_add_u32 m0, s30, 99328
    s_nop 0
    buffer_load_dwordx4 v9, s[44:47], s33 offen lds
    s_add_u32 m0, s30, 100352
    s_nop 0
    buffer_load_dwordx4 v10, s[44:47], s33 offen lds
    s_add_u32 m0, s30, 101376
    s_nop 0
    buffer_load_dwordx4 v11, s[44:47], s33 offen lds
    s_add_u32 s33, s33, s35
    s_add_u32 m0, s30, 114688
    s_nop 0
    buffer_load_dwordx4 v8, s[44:47], s33 offen lds
    s_add_u32 m0, s30, 115712
    s_nop 0
    buffer_load_dwordx4 v9, s[44:47], s33 offen lds
    s_add_u32 m0, s30, 116736
    s_nop 0
    buffer_load_dwordx4 v10, s[44:47], s33 offen lds
    s_add_u32 m0, s30, 117760
    s_nop 0
    buffer_load_dwordx4 v11, s[44:47], s33 offen lds
    s_add_u32 s33, s33, s35
    s_waitcnt vmcnt(28)
    s_barrier
    s_mov_b32 s34, 0
B_lloop:
    s_waitcnt vmcnt(24)
    s_barrier
    s_add_u32 m0, s30, 0
    s_nop 0
    buffer_load_dwordx4 v8, s[44:47], s33 offen lds
    s_add_u32 m0, s30, 1024
    s_nop 0
    buffer_load_dwordx4 v9, s[44:47], s33 offen lds
    s_add_u32 m0, s30, 2048
    s_nop 0
    buffer_load_dwordx4 v10, s[44:47], s33 offen lds
    s_add_u32 m0, s30, 3072
    s_nop 0
    buffer_load_dwordx4 v11, s[44:47], s33 offen lds
    s_add_u32 s33, s33, s35
    s_waitcnt vmcnt(24)
    s_barrier
    s_add_u32 m0, s30, 16384
    s_nop 0
    buffer_load_dwordx4 v8, s[44:47], s33 offen lds
    s_add_u32 m0, s30, 17408
    s_nop 0
    buffer_load_dwordx4 v9, s[44:47], s33 offen lds
    s_add_u32 m0, s30, 18432
    s_nop 0
    buffer_load_dwordx4 v10, s[44:47], s33 offen lds
    s_add_u32 m0, s30, 19456
    s_nop 0
    buffer_load_dwordx4 v11, s[44:47], s33 offen lds
    s_add_u32 s33, s33, s35
    s_waitcnt vmcnt(24)
    s_barrier
    s_add_u32 m0, s30, 32768
    s_nop 0
    buffer_load_dwordx4 v8, s[44:47], s33 offen lds
    s_add_u32 m0, s30, 33792
    s_nop 0
    buffer_load_dwordx4 v9, s[44:47], s33 offen lds
    s_add_u32 m0, s30, 34816
    s_nop 0
    buffer_load_dwordx4 v10, s[44:47], s33 offen lds
    s_add_u32 m0, s30, 35840
    s_nop 0
    buffer_load_dwordx4 v11, s[44:47], s33 offen lds
    s_add_u32 s33, s33, s35
    s_waitcnt vmcnt(24)
    s_barrier
    s_add_u32 m0, s30, 49152
    s_nop 0
    buffer_load_dwordx4 v8, s[44:47], s33 offen lds
    s_add_u32 m0, s30, 50176
    s_nop 0
    buffer_load_dwordx4 v9, s[44:47], s33 offen lds
    s_add_u32 m0, s30, 51200
    s_nop 0
    buffer_load_dwordx4 v10, s[44:47], s33 offen lds
    s_add_u32 m0, s30, 52224
    s_nop 0
    buffer_load_dwordx4 v11, s[44:47], s33 offen lds
    s_add_u32 s33, s33, s35
    s_waitcnt vmcnt(24)
    s_barrier
    s_add_u32 m0, s30, 65536
    s_nop 0
    buffer_load_dwordx4 v8, s[44:47], s33 offen lds
    s_add_u32 m0, s30, 66560
    s_nop 0
    buffer_load_dwordx4 v9, s[44:47], s33 offen lds
    s_add_u32 m0, s30, 67584
    s_nop 0
    buffer_load_dwordx4 v10, s[44:47], s33 offen lds
    s_add_u32 m0, s30, 68608
    s_nop 0
    buffer_load_dwordx4 v11, s[44:47], s33 offen lds
    s_add_u32 s33, s33, s35
    s_waitcnt vmcnt(24)
    s_barrier
    s_add_u32 m0, s30, 81920
    s_nop 0
    buffer_load_dwordx4 v8, s[44:47], s33 offen lds
    s_add_u32 m0, s30, 82944
    s_nop 0
    buffer_load_dwordx4 v9, s[44:47], s33 offen lds
    s_add_u32 m0, s30, 83968
    s_nop 0
    buffer_load_dwordx4 v10, s[44:47], s33 offen lds
    s_add_u32 m0, s30, 84992
    s_nop 0
    buffer_load_dwordx4 v11, s[44:47], s33 offen lds
    s_add_u32 s33, s33, s35
    s_waitcnt vmcnt(24)
    s_barrier
    s_add_u32 m0, s30, 98304
    s_nop 0
    buffer_load_dwordx4 v8, s[44:47], s33 offen lds
    s_add_u32 m0, s30, 99328
    s_nop 0
    buffer_load_dwordx4 v9, s[44:47], s33 offen lds
    s_add_u32 m0, s30, 100352
    s_nop 0
    buffer_load_dwordx4 v10, s[44:47], s33 offen lds
    s_add_u32 m0, s30, 101376
    s_nop 0
    buffer_load_dwordx4 v11, s[44:47], s33 offen lds
    s_add_u32 s33, s33, s35
    s_waitcnt vmcnt(24)
    s_barrier
    s_add_u32 m0, s30, 114688
    s_nop 0
    buffer_load_dwordx4 v8, s[44:47], s33 offen lds
    s_add_u32 m0, s30, 115712
    s_nop 0
    buffer_load_dwordx4 v9, s[44:47], s33 offen lds
    s_add_u32 m0, s30, 116736
    s_nop 0
    buffer_load_dwordx4 v10, s[44:47], s33 offen lds
    s_add_u32 m0, s30, 117760
    s_nop 0
    buffer_load_dwordx4 v11, s[44:47], s33 offen lds
    s_add_u32 s33, s33, s35
    s_add_u32 s34, s34, 1
    s_cmp_lt_u32 s34, 6
    s_cbranch_scc1 B_lloop
B_done:
    s_endpgm
.section .rodata,"a"
.p2align 6
.amdhsa_kernel attn_kernel
  .amdhsa_next_free_vgpr 256
  .amdhsa_next_free_sgpr 64
  .amdhsa_accum_offset 256
  .amdhsa_group_segment_fixed_size 0
  .amdhsa_kernarg_size 64
  .amdhsa_user_sgpr_count 2
  .amdhsa_user_sgpr_kernarg_segment_ptr 1
  .amdhsa_system_sgpr_workgroup_id_x 1
.end_amdhsa_kernel
.p2align 6
.amdhsa_kernel oproj_kernel
  .amdhsa_next_free_vgpr 256
  .amdhsa_next_free_sgpr 64
  .amdhsa_accum_offset 256
  .amdhsa_group_segment_fixed_size 0
  .amdhsa_kernarg_size 64
  .amdhsa_user_sgpr_count 2
  .amdhsa_user_sgpr_kernarg_segment_ptr 1
  .amdhsa_system_sgpr_workgroup_id_x 1
.end_amdhsa_kernel
```
